```python
import torch

def _softmax(x, axis=-1):
    return torch.softmax(x, dim=axis)
def _gelu(x):
    return torch.nn.functional.gelu(x, approximate="tanh")
def _silu(x):
    return torch.nn.functional.silu(x)
def _sigmoid(x):
    return torch.sigmoid(x)
def _layernorm(x, axis=-1, eps=1e-5):
    m = x.mean(dim=axis, keepdim=True)
    v = x.var(dim=axis, keepdim=True, unbiased=False)
    return (x - m) / torch.sqrt(v + eps)
def _scatter_add(tgt, idx, src, axis=0):
    return tgt.clone().index_add_(axis, idx, src)
def _segment_sum(src, seg, n):
    out = torch.zeros((n,) + src.shape[1:], dtype=src.dtype)
    return out.index_add_(0, seg, src)
def _pad(x, pw):
    flat = tuple(v for pair in reversed(pw) for v in pair)
    return torch.nn.functional.pad(x, flat)

kernel_name = 'gated_mix__sliding_block_cached__glu_gated_reglu__decode'

def setup_inputs():

    _w = (lambda a: (lambda t: t.to(torch.bfloat16) if t.is_floating_point() else t)(torch.as_tensor(a)))
    def _A_setup():
        B, Sq, D = 4, 1, 576
        Hq, Hkv, Sk, Dh = 32, 16, 4096, 128
        assert Hq % Hkv == 0, (Hq, Hkv)
        return {
            "x": _w((lambda *s: torch.randn(*s, dtype=torch.bfloat16) * 0.05)(B, Sq, D)),
            "k_cache": _w((lambda *s: torch.randn(*s, dtype=torch.bfloat16) * 3.2)(B, Hkv, Sk, Dh)),
            "v_cache": _w((lambda *s: torch.randn(*s, dtype=torch.bfloat16) * 0.05)(B, Hkv, Sk, Dh)),
            "wq": _w((lambda *s: torch.randn(*s, dtype=torch.bfloat16) * 3.2)(D, Hq * Dh) * (D ** -0.5)),
            "wo": _w((lambda *s: torch.randn(*s, dtype=torch.bfloat16) * 0.05)(Hq * Dh, D) * ((Hq * Dh) ** -0.5)),
        }
    _A_in = _A_setup()

    def _B_setup():
        B, S, D, F = 4, 1, 576, 4608
        return {
            "x": _w((lambda *s: torch.randn(*s, dtype=torch.bfloat16) * 0.05)(B, S, D)),
            "W_gate": _w((lambda *s: torch.randn(*s, dtype=torch.bfloat16) * 0.2)(D, F) * (2.0 / D) ** 0.5),
            "W_up": _w((lambda *s: torch.randn(*s, dtype=torch.bfloat16) * 0.2)(D, F) * (2.0 / D) ** 0.5),
            "W_down": _w((lambda *s: torch.randn(*s, dtype=torch.bfloat16) * 0.2)(F, D) * (1.0 / F) ** 0.5),
        }
    _B_in = _B_setup()

    return {
        "A_x": _A_in["x"],
        "A_k_cache": _A_in["k_cache"],
        "A_v_cache": _A_in["v_cache"],
        "A_wq": _A_in["wq"],
        "A_wo": _A_in["wo"],
        "B_x": _B_in["x"],
        "B_W_gate": _B_in["W_gate"],
        "B_W_up": _B_in["W_up"],
        "B_W_down": _B_in["W_down"],
        "gate_w": _w((lambda *s: torch.randn(*s, dtype=torch.bfloat16) * 0.05)(576) * 16.0),
    }

def reference(A_x, A_k_cache, A_v_cache, A_wq, A_wo, B_x, B_W_gate, B_W_up, B_W_down, gate_w):
    def _A_ref(x, k_cache, v_cache, wq, wo):
        B, Sq, D = x.shape
        Hq, Dh = 32, 128
        Hkv, Sk = k_cache.shape[1], k_cache.shape[2]
        W = min(4096, max(256, Sk // 4))
        rep = Hq // Hkv
        q = (lambda x, *d: x.permute(*d))((x @ wq).reshape(B, Sq, Hq, Dh), 0, 2, 1, 3)
        k = (lambda x, n, axis: torch.repeat_interleave(x, n, dim=axis))(k_cache[:, :, Sk - W:, :], rep, axis=1)
        v = (lambda x, n, axis: torch.repeat_interleave(x, n, dim=axis))(v_cache[:, :, Sk - W:, :], rep, axis=1)
        scores = torch.einsum("bhqd,bhkd->bhqk", q, k) * (Dh ** -0.5)
        p = _softmax(scores, axis=-1)
        o = torch.einsum("bhqk,bhkd->bhqd", p, v)
        return (lambda x, *d: x.permute(*d))(o, 0, 2, 1, 3).reshape(B, Sq, Hq * Dh) @ wo

    def _B_ref(x, W_gate, W_up, W_down):
        gate = torch.einsum("bsd,df->bsf", x, W_gate)
        up = torch.einsum("bsd,df->bsf", x, W_up)
        gate = gate * (lambda x, dt: x.to(dt))(gate > 0, gate.dtype)
        h = gate * up
        return torch.einsum("bsf,fd->bsd", h, W_down)

    x = A_x
    g = _sigmoid((x * gate_w).sum(-1, keepdims=True))
    a = _A_ref(x, A_k_cache, A_v_cache, A_wq, A_wo)
    b = _B_ref(x, B_W_gate, B_W_up, B_W_down)
    return g * a + (1 - g) * b
```

```asm
; @launch grid=(256,1,1) block=(512,1,1) lds=162560
.amdgcn_target "amdgcn-amd-amdhsa--gfx950"
.text
.globl gated_mix__sliding_block_cached__glu_gated_reglu__decode_kernel
.p2align 8
.type gated_mix__sliding_block_cached__glu_gated_reglu__decode_kernel,@function
gated_mix__sliding_block_cached__glu_gated_reglu__decode_kernel:
    s_cmpk_ge_u32 s2, 256
    s_cbranch_scc1 L_end
    s_load_dwordx2 s[48:49], s[0:1], 8
    s_load_dwordx16 s[16:31], s[0:1], 0
    s_load_dwordx8 s[32:39], s[0:1], 64
    s_load_dwordx2 s[40:41], s[0:1], 96
    v_lshrrev_b32 v1, 6, v0
    s_getpc_b64 s[44:45]
    v_lshlrev_b32 v4, 4, v0
    global_load_dwordx4 v[156:159], v4, s[44:45] offset:208
    v_and_b32 v0, 63, v0
    s_lshr_b32 s5, s2, 5
    v_readfirstlane_b32 s3, v1
    v_lshrrev_b32 v2, 4, v0
    v_and_b32 v3, 15, v0
    s_lshl_b32 s5, s5, 23
    s_and_b32 s4, s2, 7
    s_lshl_b32 s6, s4, 20
    s_or_b32 s5, s5, s6
    s_and_b32 s6, s2, 24
    s_lshl_b32 s6, s6, 13
    s_or_b32 s5, s5, s6
    s_add_u32 s69, s5, 0xc0000
    s_lshr_b32 s5, s2, 3
    s_add_u32 s5, s5, s2
    s_lshl_b32 s64, s5, 13
    s_and_b32 s64, s64, 0xffff
    s_lshl_b32 s5, s3, 10
    s_mov_b32 m0, s5
    s_add_u32 s5, s5, s64
    s_and_b32 s5, s5, 0xffff
    s_add_u32 s5, s5, s69
    v_xor_b32 v5, v3, v2
    v_lshlrev_b32 v5, 4, v5
    v_lshl_add_u32 v10, v2, 8, v5
    s_and_b32 s6, s3, 3
    s_lshl_b32 s6, s6, 6
    v_xor_b32 v6, s6, v10
    s_brev_b32 s50, 32
    s_mov_b32 s51, 0x20000
    s_lshr_b32 s9, s2, 6
    s_bfe_u32 s10, s2, 0x20003
    s_lshl2_add_u32 s7, s9, s10
    s_waitcnt lgkmcnt(0)
    buffer_load_dwordx4 v6, s[48:51], s5 offen offset:0 nt lds
L_first_end:
    s_bfe_u32 s6, s2, 0x10005
    s_lshl3_add_u32 s8, s6, s4
    s_mul_i32 s42, s4, 9
    s_sub_u32 s42, s42, 7
    s_lshl_b32 s43, s8, 2
    s_sub_u32 s43, s43, 3
    s_cmp_lt_u32 s7, 7
    s_cselect_b32 s42, s43, s42
    s_add_u32 s42, s42, s7
    s_cmp_ge_u32 s3, 4
    s_cbranch_scc1 L_compute
    s_lshl_b32 s67, s3, 10
    s_mov_b32 s47, 0x20000
    s_cmp_lt_u32 s7, 3
    s_cbranch_scc1 L_hd_wo
    s_cmp_lt_u32 s7, 7
    s_cbranch_scc1 L_hd_q
    s_lshr_b32 s43, s3, 1
    s_lshl_b32 s43, s43, 2
    v_xor_b32 v7, s43, v2
    v_lshlrev_b32 v7, 1, v7
    v_xor_b32 v7, v7, v3
    v_lshlrev_b32 v7, 4, v7
    s_and_b32 s43, s42, 1
    s_mul_i32 s43, s43, 72
    s_add_u32 s43, s43, s3
    s_mul_i32 s43, s43, 36864
    s_lshr_b32 s70, s42, 1
    s_lshl_b32 s70, s70, 8
    s_add_u32 s70, s70, s43
    v_mul_u32_u24 v6, 9216, v2
    v_add_u32 v8, v6, v7
    s_cmp_eq_u32 s6, 0
    s_cselect_b32 s44, s28, s30
    s_cselect_b32 s45, s29, s31
    s_mov_b32 s46, 5308416
    s_add_u32 m0, s67, 65536
    s_nop 0
    buffer_load_dwordx4 v8, s[44:47], s70 offen nt lds
    s_add_u32 m0, s67, 69632
    s_add_u32 s70, s70, 147456
    buffer_load_dwordx4 v8, s[44:47], s70 offen nt lds
    s_add_u32 m0, s67, 73728
    s_add_u32 s70, s70, 147456
    buffer_load_dwordx4 v8, s[44:47], s70 offen nt lds
    s_mov_b32 s52, s20
    s_mov_b32 s53, s21
    s_mov_b32 s54, s50
    s_mov_b32 s55, 0x20000
    s_add_u32 s69, s69, s67
    s_mov_b32 s65, s64
    s_add_u32 s64, s64, 8192
    s_and_b32 s64, s64, 0xffff
    s_lshl_b32 s4, s3, 6
    v_xor_b32 v10, s4, v10
    v_lshl_add_u32 v11, v2, 8, v7
    v_lshrrev_b32 v4, 3, v0
    v_and_b32 v5, 1, v2
    s_and_b32 s43, s3, 1
    s_lshl_b32 s43, s43, 1
    v_xor_b32 v5, s43, v5
    v_lshlrev_b32 v5, 1, v5
    v_and_b32 v6, 7, v0
    v_xor_b32 v5, v5, v6
    v_lshlrev_b32 v5, 4, v5
    s_mul_i32 s12, s6, 9
    s_add_u32 s12, s12, s7
    s_sub_u32 s12, s12, 1
    s_lshr_b32 s13, s12, 3
    s_and_b32 s14, s12, 7
    s_mov_b32 s75, 0
    s_mul_i32 s12, s13, 24
    s_and_b32 s5, s2, 7
    s_mul_i32 s4, s5, 72
    s_add_u32 s12, s12, s4
    s_mul_i32 s4, s5, 3
    s_add_u32 s13, s13, s4
    v_mul_u32_u24 v6, 1152, v4
    v_add_u32 v9, v6, v5
    s_add_u32 s73, s12, s3
    s_mul_i32 s73, s73, 9216
    s_lshl_b32 s43, s14, 7
    s_add_u32 s73, s73, s43
    s_mov_b32 s56, s32
    s_mov_b32 s57, s33
    s_mov_b32 s58, 5308416
    s_mov_b32 s59, 0x20000
    s_waitcnt vmcnt(4)
    s_add_u32 m0, s67, 77824
    s_add_u32 s70, s70, 147456
    buffer_load_dwordx4 v8, s[44:47], s70 offen nt lds
    s_waitcnt vmcnt(4)
    s_add_u32 m0, s67, 81920
    s_add_u32 s70, s70, 147456
    buffer_load_dwordx4 v8, s[44:47], s70 offen nt lds
    s_waitcnt vmcnt(4)
    s_add_u32 m0, s67, 86016
    s_add_u32 s70, s70, 147456
    buffer_load_dwordx4 v8, s[44:47], s70 offen nt lds
    s_waitcnt vmcnt(4)
    s_add_u32 m0, s67, 90112
    s_add_u32 s70, s70, 147456
    buffer_load_dwordx4 v8, s[44:47], s70 offen nt lds
    s_waitcnt vmcnt(4)
    s_add_u32 m0, s67, 94208
    s_add_u32 s70, s70, 147456
    buffer_load_dwordx4 v8, s[44:47], s70 offen nt lds
    s_waitcnt vmcnt(4)
    s_add_u32 m0, s67, 98304
    s_add_u32 s70, s70, 147456
    buffer_load_dwordx4 v8, s[44:47], s70 offen nt lds
    s_waitcnt vmcnt(4)
    s_add_u32 m0, s67, 102400
    s_add_u32 s70, s70, 147456
    buffer_load_dwordx4 v8, s[44:47], s70 offen nt lds
    s_waitcnt vmcnt(4)
    s_add_u32 m0, s67, 106496
    s_add_u32 s70, s70, 147456
    buffer_load_dwordx4 v8, s[44:47], s70 offen nt lds
    s_waitcnt vmcnt(4)
    s_add_u32 m0, s67, 110592
    s_add_u32 s70, s70, 147456
    buffer_load_dwordx4 v8, s[44:47], s70 offen nt lds
    s_waitcnt vmcnt(4)
    s_add_u32 m0, s67, 114688
    s_add_u32 s70, s70, 147456
    buffer_load_dwordx4 v8, s[44:47], s70 offen nt lds
    s_waitcnt vmcnt(4)
    s_add_u32 m0, s67, 118784
    s_add_u32 s70, s70, 147456
    buffer_load_dwordx4 v8, s[44:47], s70 offen nt lds
    s_waitcnt vmcnt(4)
    s_add_u32 m0, s67, 122880
    s_add_u32 s70, s70, 147456
    buffer_load_dwordx4 v8, s[44:47], s70 offen nt lds
    s_waitcnt vmcnt(4)
    s_add_u32 m0, s67, 126976
    s_add_u32 s70, s70, 147456
    buffer_load_dwordx4 v8, s[44:47], s70 offen nt lds
    s_waitcnt vmcnt(4)
    s_add_u32 m0, s67, 131072
    s_add_u32 s70, s70, 147456
    buffer_load_dwordx4 v8, s[44:47], s70 offen nt lds
    s_waitcnt vmcnt(4)
    s_add_u32 m0, s67, 135168
    s_add_u32 s70, s70, 147456
    buffer_load_dwordx4 v8, s[44:47], s70 offen nt lds
    s_waitcnt vmcnt(4)
    s_add_u32 m0, s67, 8192
    s_add_u32 s4, s64, s69
    buffer_load_dwordx4 v10, s[48:51], s4 offen nt lds
    s_add_u32 s64, s64, 4096
    s_waitcnt vmcnt(4)
    s_add_u32 m0, s67, 12288
    s_add_u32 s4, s64, s69
    buffer_load_dwordx4 v10, s[48:51], s4 offen nt lds
    s_add_u32 s64, s64, 4096
    s_and_b32 s64, s64, 0xffff
    s_waitcnt vmcnt(4)
    s_add_u32 m0, s67, 16384
    s_add_u32 s4, s64, s69
    buffer_load_dwordx4 v10, s[48:51], s4 offen nt lds
    s_add_u32 s64, s64, 4096
    s_waitcnt vmcnt(4)
    s_add_u32 m0, s67, 20480
    s_add_u32 s4, s64, s69
    buffer_load_dwordx4 v10, s[48:51], s4 offen nt lds
    s_add_u32 s64, s64, 4096
    s_and_b32 s64, s64, 0xffff
    s_waitcnt vmcnt(4)
    s_add_u32 m0, s67, 24576
    s_add_u32 s4, s64, s69
    buffer_load_dwordx4 v10, s[48:51], s4 offen nt lds
    s_add_u32 s64, s64, 4096
    s_waitcnt vmcnt(5)
    s_barrier
    s_waitcnt vmcnt(4)
    s_add_u32 m0, s67, 28672
    s_add_u32 s4, s64, s69
    buffer_load_dwordx4 v10, s[48:51], s4 offen nt lds
    s_add_u32 s64, s64, 4096
    s_and_b32 s64, s64, 0xffff
    s_waitcnt vmcnt(4)
    s_add_u32 m0, s67, 32768
    s_add_u32 s4, s64, s69
    buffer_load_dwordx4 v10, s[48:51], s4 offen nt lds
    s_add_u32 s64, s64, 4096
    s_waitcnt vmcnt(4)
    s_add_u32 m0, s67, 36864
    s_add_u32 s4, s64, s69
    buffer_load_dwordx4 v10, s[48:51], s4 offen nt lds
    s_add_u32 s64, s64, 4096
    s_and_b32 s64, s64, 0xffff
    s_waitcnt vmcnt(4)
    s_add_u32 m0, s67, 40960
    s_add_u32 s4, s64, s69
    buffer_load_dwordx4 v10, s[48:51], s4 offen nt lds
    s_add_u32 s64, s64, 4096
    s_waitcnt vmcnt(4)
    s_add_u32 m0, s67, 45056
    s_add_u32 s4, s64, s69
    buffer_load_dwordx4 v10, s[48:51], s4 offen nt lds
    s_add_u32 s64, s64, 4096
    s_and_b32 s64, s64, 0xffff
    s_waitcnt vmcnt(4)
    s_add_u32 m0, s67, 49152
    s_add_u32 s4, s64, s69
    buffer_load_dwordx4 v10, s[48:51], s4 offen nt lds
    s_add_u32 s64, s64, 4096
    s_waitcnt vmcnt(4)
    s_add_u32 m0, s67, 53248
    s_add_u32 s4, s64, s69
    buffer_load_dwordx4 v10, s[48:51], s4 offen nt lds
    s_add_u32 s64, s64, 4096
    s_and_b32 s64, s64, 0xffff
    s_waitcnt vmcnt(4)
    s_add_u32 m0, s67, 57344
    s_add_u32 s4, s64, s69
    buffer_load_dwordx4 v10, s[48:51], s4 offen nt lds
    s_add_u32 s64, s64, 4096
    s_waitcnt vmcnt(4)
    s_add_u32 m0, s67, 61440
    s_add_u32 s4, s64, s69
    buffer_load_dwordx4 v10, s[48:51], s4 offen nt lds
    s_barrier
    s_waitcnt vmcnt(5)
    s_add_u32 m0, s67, 65536
    s_add_u32 s4, s65, s69
    buffer_load_dwordx4 v11, s[52:55], s4 offen nt lds
    s_add_u32 s65, s65, 4096
    s_waitcnt vmcnt(5)
    s_add_u32 m0, s67, 69632
    s_add_u32 s4, s65, s69
    buffer_load_dwordx4 v11, s[52:55], s4 offen nt lds
    s_add_u32 s65, s65, 4096
    s_and_b32 s65, s65, 0xffff
    s_waitcnt vmcnt(5)
    s_add_u32 m0, s67, 73728
    s_add_u32 s4, s65, s69
    buffer_load_dwordx4 v11, s[52:55], s4 offen nt lds
    s_add_u32 s65, s65, 4096
    s_waitcnt vmcnt(5)
    s_add_u32 m0, s67, 77824
    s_add_u32 s4, s65, s69
    buffer_load_dwordx4 v11, s[52:55], s4 offen nt lds
    s_add_u32 s65, s65, 4096
    s_and_b32 s65, s65, 0xffff
    s_waitcnt vmcnt(5)
    s_add_u32 m0, s67, 81920
    s_add_u32 s4, s65, s69
    buffer_load_dwordx4 v11, s[52:55], s4 offen nt lds
    s_add_u32 s65, s65, 4096
    s_waitcnt vmcnt(5)
    s_add_u32 m0, s67, 86016
    s_add_u32 s4, s65, s69
    buffer_load_dwordx4 v11, s[52:55], s4 offen nt lds
    s_add_u32 s65, s65, 4096
    s_and_b32 s65, s65, 0xffff
    s_waitcnt vmcnt(6)
    s_barrier
    s_waitcnt vmcnt(5)
    s_add_u32 m0, s67, 90112
    s_add_u32 s4, s65, s69
    buffer_load_dwordx4 v11, s[52:55], s4 offen nt lds
    s_add_u32 s65, s65, 4096
    s_waitcnt vmcnt(5)
    s_add_u32 m0, s67, 94208
    s_add_u32 s4, s65, s69
    buffer_load_dwordx4 v11, s[52:55], s4 offen nt lds
    s_add_u32 s65, s65, 4096
    s_and_b32 s65, s65, 0xffff
    s_waitcnt vmcnt(5)
    s_add_u32 m0, s67, 98304
    s_add_u32 s4, s65, s69
    buffer_load_dwordx4 v11, s[52:55], s4 offen nt lds
    s_add_u32 s65, s65, 4096
    s_waitcnt vmcnt(5)
    s_add_u32 m0, s67, 102400
    s_add_u32 s4, s65, s69
    buffer_load_dwordx4 v11, s[52:55], s4 offen nt lds
    s_add_u32 s65, s65, 4096
    s_and_b32 s65, s65, 0xffff
    s_waitcnt vmcnt(5)
    s_add_u32 m0, s67, 106496
    s_add_u32 s4, s65, s69
    buffer_load_dwordx4 v11, s[52:55], s4 offen nt lds
    s_add_u32 s65, s65, 4096
    s_waitcnt vmcnt(5)
    s_add_u32 m0, s67, 110592
    s_add_u32 s4, s65, s69
    buffer_load_dwordx4 v11, s[52:55], s4 offen nt lds
    s_add_u32 s65, s65, 4096
    s_and_b32 s65, s65, 0xffff
    s_waitcnt vmcnt(5)
    s_add_u32 m0, s67, 114688
    s_add_u32 s4, s65, s69
    buffer_load_dwordx4 v11, s[52:55], s4 offen nt lds
    s_add_u32 s65, s65, 4096
    s_waitcnt vmcnt(5)
    s_add_u32 m0, s67, 118784
    s_add_u32 s4, s65, s69
    buffer_load_dwordx4 v11, s[52:55], s4 offen nt lds
    s_add_u32 s65, s65, 4096
    s_and_b32 s65, s65, 0xffff
    s_waitcnt vmcnt(5)
    s_add_u32 m0, s67, 122880
    s_add_u32 s4, s65, s69
    buffer_load_dwordx4 v11, s[52:55], s4 offen nt lds
    s_add_u32 s65, s65, 4096
    s_waitcnt vmcnt(5)
    s_add_u32 m0, s67, 126976
    s_add_u32 s4, s65, s69
    buffer_load_dwordx4 v11, s[52:55], s4 offen nt lds
    s_waitcnt vmcnt(5)
    s_add_u32 m0, s67, 131072
    s_nop 0
    buffer_load_dwordx4 v9, s[56:59], s73 offen nt lds
    s_waitcnt vmcnt(5)
    s_add_u32 m0, s67, 135168
    s_add_u32 s73, s73, 36864
    buffer_load_dwordx4 v9, s[56:59], s73 offen nt lds
    s_waitcnt vmcnt(6)
    s_barrier
    s_waitcnt vmcnt(5)
    s_add_u32 m0, s67, 139264
    s_add_u32 s73, s73, 36864
    buffer_load_dwordx4 v9, s[56:59], s73 offen nt lds
    s_waitcnt vmcnt(3)
    s_barrier
    s_barrier
    s_waitcnt vmcnt(15)
    s_add_u32 m0, s67, 143360
    s_add_u32 s73, s73, 36864
    buffer_load_dwordx4 v9, s[56:59], s73 offen nt lds
    s_waitcnt vmcnt(15)
    s_add_u32 m0, s67, 147456
    s_add_u32 s73, s73, 36864
    buffer_load_dwordx4 v9, s[56:59], s73 offen nt lds
    s_waitcnt vmcnt(15)
    s_add_u32 m0, s67, 151552
    s_add_u32 s73, s73, 36864
    buffer_load_dwordx4 v9, s[56:59], s73 offen nt lds
    s_waitcnt vmcnt(0)
    s_barrier
    s_endpgm
L_ld_q:
L_hd_q:
    s_lshr_b32 s43, s3, 1
    s_lshl_b32 s43, s43, 2
    v_xor_b32 v7, s43, v2
    v_lshlrev_b32 v7, 1, v7
    v_xor_b32 v7, v7, v3
    v_lshlrev_b32 v7, 4, v7
    s_and_b32 s43, s42, 1
    s_mul_i32 s43, s43, 72
    s_add_u32 s43, s43, s3
    s_mul_i32 s43, s43, 32768
    s_lshr_b32 s70, s42, 1
    s_lshl_b32 s70, s70, 8
    s_add_u32 s70, s70, s43
    v_mul_u32_u24 v6, 8192, v2
    v_add_u32 v8, v6, v7
    s_mov_b32 s44, s22
    s_mov_b32 s45, s23
    s_mov_b32 s46, 4718592
    s_add_u32 m0, s67, 65536
    s_nop 0
    buffer_load_dwordx4 v8, s[44:47], s70 offen nt lds
    s_add_u32 m0, s67, 69632
    s_add_u32 s70, s70, 131072
    buffer_load_dwordx4 v8, s[44:47], s70 offen nt lds
    s_add_u32 m0, s67, 73728
    s_add_u32 s70, s70, 131072
    buffer_load_dwordx4 v8, s[44:47], s70 offen nt lds
    s_mov_b32 s52, s20
    s_mov_b32 s53, s21
    s_mov_b32 s54, s50
    s_mov_b32 s55, 0x20000
    s_add_u32 s69, s69, s67
    s_mov_b32 s65, s64
    s_add_u32 s64, s64, 8192
    s_and_b32 s64, s64, 0xffff
    s_lshl_b32 s4, s3, 6
    v_xor_b32 v10, s4, v10
    v_lshl_add_u32 v11, v2, 8, v7
    v_lshrrev_b32 v4, 3, v0
    v_and_b32 v5, 1, v2
    s_and_b32 s43, s3, 1
    s_lshl_b32 s43, s43, 1
    v_xor_b32 v5, s43, v5
    v_lshlrev_b32 v5, 1, v5
    v_and_b32 v6, 7, v0
    v_xor_b32 v5, v5, v6
    v_lshlrev_b32 v5, 4, v5
    s_lshl2_add_u32 s12, s6, s7
    s_sub_u32 s12, s12, 3
    s_cmp_lt_u32 s12, 2
    s_cselect_b32 s75, 1, 0
    s_cselect_b32 s13, s12, 0
    s_cselect_b32 s14, 10, s12
    s_sub_u32 s14, s14, 2
    s_mul_i32 s12, s13, 36
    s_and_b32 s5, s2, 7
    s_mul_i32 s4, s5, 72
    s_add_u32 s12, s12, s4
    s_mul_i32 s4, s5, 3
    s_add_u32 s13, s13, s4
    v_mul_u32_u24 v6, 1152, v4
    v_add_u32 v9, v6, v5
    s_add_u32 s73, s12, s3
    s_mul_i32 s73, s73, 9216
    s_lshl_b32 s43, s14, 7
    s_add_u32 s73, s73, s43
    s_mov_b32 s56, s32
    s_mov_b32 s57, s33
    s_mov_b32 s58, 5308416
    s_mov_b32 s59, 0x20000
    s_load_dword s15, s[40:41], 428032
    s_add_u32 m0, s67, 77824
    s_add_u32 s70, s70, 131072
    buffer_load_dwordx4 v8, s[44:47], s70 offen nt lds
    s_add_u32 m0, s67, 81920
    s_add_u32 s70, s70, 131072
    buffer_load_dwordx4 v8, s[44:47], s70 offen nt lds
    s_waitcnt vmcnt(6)
    s_add_u32 m0, s67, 86016
    s_add_u32 s70, s70, 131072
    buffer_load_dwordx4 v8, s[44:47], s70 offen nt lds
    s_waitcnt vmcnt(6)
    s_add_u32 m0, s67, 90112
    s_add_u32 s70, s70, 131072
    buffer_load_dwordx4 v8, s[44:47], s70 offen nt lds
    s_waitcnt vmcnt(6)
    s_add_u32 m0, s67, 94208
    s_add_u32 s70, s70, 131072
    buffer_load_dwordx4 v8, s[44:47], s70 offen nt lds
    s_waitcnt vmcnt(6)
    s_add_u32 m0, s67, 98304
    s_add_u32 s70, s70, 131072
    buffer_load_dwordx4 v8, s[44:47], s70 offen nt lds
    s_waitcnt vmcnt(6)
    s_add_u32 m0, s67, 102400
    s_add_u32 s70, s70, 131072
    buffer_load_dwordx4 v8, s[44:47], s70 offen nt lds
    s_waitcnt vmcnt(6)
    s_add_u32 m0, s67, 106496
    s_add_u32 s70, s70, 131072
    buffer_load_dwordx4 v8, s[44:47], s70 offen nt lds
    s_waitcnt vmcnt(6)
    s_add_u32 m0, s67, 110592
    s_add_u32 s70, s70, 131072
    buffer_load_dwordx4 v8, s[44:47], s70 offen nt lds
    s_waitcnt vmcnt(6)
    s_add_u32 m0, s67, 114688
    s_add_u32 s70, s70, 131072
    buffer_load_dwordx4 v8, s[44:47], s70 offen nt lds
    s_waitcnt vmcnt(6)
    s_add_u32 m0, s67, 118784
    s_add_u32 s70, s70, 131072
    buffer_load_dwordx4 v8, s[44:47], s70 offen nt lds
    s_waitcnt vmcnt(6)
    s_add_u32 m0, s67, 122880
    s_add_u32 s70, s70, 131072
    buffer_load_dwordx4 v8, s[44:47], s70 offen nt lds
    s_waitcnt vmcnt(6)
    s_add_u32 m0, s67, 126976
    s_add_u32 s70, s70, 131072
    buffer_load_dwordx4 v8, s[44:47], s70 offen nt lds
    s_waitcnt vmcnt(6)
    s_add_u32 m0, s67, 131072
    s_add_u32 s70, s70, 131072
    buffer_load_dwordx4 v8, s[44:47], s70 offen nt lds
    s_waitcnt vmcnt(6)
    s_add_u32 m0, s67, 135168
    s_add_u32 s70, s70, 131072
    buffer_load_dwordx4 v8, s[44:47], s70 offen nt lds
    s_waitcnt vmcnt(5)
    s_add_u32 m0, s67, 8192
    s_add_u32 s4, s64, s69
    buffer_load_dwordx4 v10, s[48:51], s4 offen nt lds
    s_add_u32 s64, s64, 4096
    s_waitcnt vmcnt(5)
    s_add_u32 m0, s67, 12288
    s_add_u32 s4, s64, s69
    buffer_load_dwordx4 v10, s[48:51], s4 offen nt lds
    s_add_u32 s64, s64, 4096
    s_and_b32 s64, s64, 0xffff
    s_waitcnt vmcnt(5)
    s_add_u32 m0, s67, 16384
    s_add_u32 s4, s64, s69
    buffer_load_dwordx4 v10, s[48:51], s4 offen nt lds
    s_add_u32 s64, s64, 4096
    s_waitcnt vmcnt(3)
    s_waitcnt lgkmcnt(0)
    s_barrier
    s_waitcnt vmcnt(5)
    s_add_u32 m0, s67, 20480
    s_add_u32 s4, s64, s69
    buffer_load_dwordx4 v10, s[48:51], s4 offen nt lds
    s_add_u32 s64, s64, 4096
    s_and_b32 s64, s64, 0xffff
    s_waitcnt vmcnt(5)
    s_add_u32 m0, s67, 24576
    s_add_u32 s4, s64, s69
    buffer_load_dwordx4 v10, s[48:51], s4 offen nt lds
    s_add_u32 s64, s64, 4096
    s_waitcnt vmcnt(5)
    s_add_u32 m0, s67, 28672
    s_add_u32 s4, s64, s69
    buffer_load_dwordx4 v10, s[48:51], s4 offen nt lds
    s_add_u32 s64, s64, 4096
    s_and_b32 s64, s64, 0xffff
    s_waitcnt vmcnt(5)
    s_add_u32 m0, s67, 32768
    s_add_u32 s4, s64, s69
    buffer_load_dwordx4 v10, s[48:51], s4 offen nt lds
    s_add_u32 s64, s64, 4096
    s_waitcnt vmcnt(5)
    s_add_u32 m0, s67, 36864
    s_add_u32 s4, s64, s69
    buffer_load_dwordx4 v10, s[48:51], s4 offen nt lds
    s_add_u32 s64, s64, 4096
    s_and_b32 s64, s64, 0xffff
    s_waitcnt vmcnt(5)
    s_add_u32 m0, s67, 40960
    s_add_u32 s4, s64, s69
    buffer_load_dwordx4 v10, s[48:51], s4 offen nt lds
    s_add_u32 s64, s64, 4096
    s_waitcnt vmcnt(5)
    s_add_u32 m0, s67, 45056
    s_add_u32 s4, s64, s69
    buffer_load_dwordx4 v10, s[48:51], s4 offen nt lds
    s_add_u32 s64, s64, 4096
    s_and_b32 s64, s64, 0xffff
    s_waitcnt vmcnt(5)
    s_add_u32 m0, s67, 49152
    s_add_u32 s4, s64, s69
    buffer_load_dwordx4 v10, s[48:51], s4 offen nt lds
    s_add_u32 s64, s64, 4096
    s_waitcnt vmcnt(5)
    s_add_u32 m0, s67, 53248
    s_add_u32 s4, s64, s69
    buffer_load_dwordx4 v10, s[48:51], s4 offen nt lds
    s_add_u32 s64, s64, 4096
    s_and_b32 s64, s64, 0xffff
    s_waitcnt vmcnt(5)
    s_add_u32 m0, s67, 57344
    s_add_u32 s4, s64, s69
    buffer_load_dwordx4 v10, s[48:51], s4 offen nt lds
    s_add_u32 s64, s64, 4096
    s_waitcnt vmcnt(5)
    s_add_u32 m0, s67, 61440
    s_add_u32 s4, s64, s69
    buffer_load_dwordx4 v10, s[48:51], s4 offen nt lds
    s_barrier
    s_waitcnt vmcnt(5)
    s_add_u32 m0, s67, 65536
    s_add_u32 s4, s65, s69
    buffer_load_dwordx4 v11, s[52:55], s4 offen nt lds
    s_add_u32 s65, s65, 4096
    s_waitcnt vmcnt(5)
    s_add_u32 m0, s67, 69632
    s_add_u32 s4, s65, s69
    buffer_load_dwordx4 v11, s[52:55], s4 offen nt lds
    s_add_u32 s65, s65, 4096
    s_and_b32 s65, s65, 0xffff
    s_waitcnt vmcnt(5)
    s_add_u32 m0, s67, 73728
    s_add_u32 s4, s65, s69
    buffer_load_dwordx4 v11, s[52:55], s4 offen nt lds
    s_add_u32 s65, s65, 4096
    s_waitcnt vmcnt(5)
    s_add_u32 m0, s67, 77824
    s_add_u32 s4, s65, s69
    buffer_load_dwordx4 v11, s[52:55], s4 offen nt lds
    s_add_u32 s65, s65, 4096
    s_and_b32 s65, s65, 0xffff
    s_waitcnt vmcnt(5)
    s_add_u32 m0, s67, 81920
    s_add_u32 s4, s65, s69
    buffer_load_dwordx4 v11, s[52:55], s4 offen nt lds
    s_add_u32 s65, s65, 4096
    s_waitcnt vmcnt(5)
    s_add_u32 m0, s67, 86016
    s_add_u32 s4, s65, s69
    buffer_load_dwordx4 v11, s[52:55], s4 offen nt lds
    s_add_u32 s65, s65, 4096
    s_and_b32 s65, s65, 0xffff
    s_waitcnt vmcnt(6)
    s_barrier
    s_waitcnt vmcnt(5)
    s_add_u32 m0, s67, 90112
    s_add_u32 s4, s65, s69
    buffer_load_dwordx4 v11, s[52:55], s4 offen nt lds
    s_add_u32 s65, s65, 4096
    s_waitcnt vmcnt(5)
    s_add_u32 m0, s67, 94208
    s_add_u32 s4, s65, s69
    buffer_load_dwordx4 v11, s[52:55], s4 offen nt lds
    s_add_u32 s65, s65, 4096
    s_and_b32 s65, s65, 0xffff
    s_waitcnt vmcnt(4)
    s_add_u32 m0, s67, 98304
    s_add_u32 s4, s65, s69
    buffer_load_dwordx4 v11, s[52:55], s4 offen nt lds
    s_add_u32 s65, s65, 4096
    s_waitcnt vmcnt(4)
    s_add_u32 m0, s67, 102400
    s_add_u32 s4, s65, s69
    buffer_load_dwordx4 v11, s[52:55], s4 offen nt lds
    s_add_u32 s65, s65, 4096
    s_and_b32 s65, s65, 0xffff
    s_waitcnt vmcnt(4)
    s_add_u32 m0, s67, 106496
    s_add_u32 s4, s65, s69
    buffer_load_dwordx4 v11, s[52:55], s4 offen nt lds
    s_add_u32 s65, s65, 4096
    s_waitcnt vmcnt(4)
    s_add_u32 m0, s67, 110592
    s_add_u32 s4, s65, s69
    buffer_load_dwordx4 v11, s[52:55], s4 offen nt lds
    s_add_u32 s65, s65, 4096
    s_and_b32 s65, s65, 0xffff
    s_waitcnt vmcnt(4)
    s_add_u32 m0, s67, 114688
    s_add_u32 s4, s65, s69
    buffer_load_dwordx4 v11, s[52:55], s4 offen nt lds
    s_add_u32 s65, s65, 4096
    s_waitcnt vmcnt(4)
    s_add_u32 m0, s67, 118784
    s_add_u32 s4, s65, s69
    buffer_load_dwordx4 v11, s[52:55], s4 offen nt lds
    s_add_u32 s65, s65, 4096
    s_and_b32 s65, s65, 0xffff
    s_waitcnt vmcnt(4)
    s_add_u32 m0, s67, 122880
    s_add_u32 s4, s65, s69
    buffer_load_dwordx4 v11, s[52:55], s4 offen nt lds
    s_add_u32 s65, s65, 4096
    s_waitcnt vmcnt(4)
    s_add_u32 m0, s67, 126976
    s_add_u32 s4, s65, s69
    buffer_load_dwordx4 v11, s[52:55], s4 offen nt lds
    s_waitcnt vmcnt(4)
    s_add_u32 m0, s67, 131072
    s_nop 0
    buffer_load_dwordx4 v9, s[56:59], s73 offen nt lds
    s_waitcnt vmcnt(5)
    s_barrier
    s_waitcnt vmcnt(4)
    s_add_u32 m0, s67, 135168
    s_add_u32 s73, s73, 36864
    buffer_load_dwordx4 v9, s[56:59], s73 offen nt lds
    s_waitcnt vmcnt(4)
    s_add_u32 m0, s67, 139264
    s_add_u32 s73, s73, 36864
    buffer_load_dwordx4 v9, s[56:59], s73 offen nt lds
    s_waitcnt vmcnt(4)
    s_add_u32 m0, s67, 143360
    s_add_u32 s73, s73, 36864
    buffer_load_dwordx4 v9, s[56:59], s73 offen nt lds
    s_waitcnt vmcnt(4)
    s_add_u32 m0, s67, 147456
    s_add_u32 s73, s73, 36864
    buffer_load_dwordx4 v9, s[56:59], s73 offen nt lds
    s_waitcnt vmcnt(5)
    s_barrier
    s_barrier
    s_waitcnt vmcnt(15)
    s_add_u32 m0, s67, 151552
    s_add_u32 s73, s73, 36864
    buffer_load_dwordx4 v9, s[56:59], s73 offen nt lds
    s_cmp_eq_u32 s75, 0
    s_cbranch_scc1 L_ld_small
    s_waitcnt vmcnt(15)
    s_add_u32 m0, s67, 155648
    s_add_u32 s73, s73, 36864
    buffer_load_dwordx4 v9, s[56:59], s73 offen nt lds
    s_waitcnt vmcnt(15)
    s_add_u32 m0, s67, 0
    s_add_u32 s73, s73, 36864
    buffer_load_dwordx4 v9, s[56:59], s73 offen nt lds
    s_waitcnt vmcnt(15)
    s_add_u32 m0, s67, 4096
    s_add_u32 s73, s73, 36864
    buffer_load_dwordx4 v9, s[56:59], s73 offen nt lds
L_ld_small:
    s_mov_b32 s60, s40
    s_mov_b32 s61, s41
    s_mov_b32 s62, 1067264
    s_mov_b32 s63, 0x20000
    s_add_u32 s15, s15, 1
    s_and_b32 s68, s15, 0xff
    s_sub_u32 s42, s7, 3
    s_mul_i32 s5, s8, 3
    s_add_u32 s4, s42, s5
    s_mul_i32 s5, s4, 10240
    s_lshl_b32 s43, s3, 6
    s_add_u32 s5, s5, s43
    s_add_u32 s64, s5, 698624
    s_add_u32 s65, s64, 4096
    s_add_u32 s66, s64, 8192
    v_lshrrev_b32 v4, 2, v0
    v_and_b32 v5, 3, v0
    v_lshlrev_b32 v4, 8, v4
    v_lshl_add_u32 v4, v5, 4, v4
    v_lshlrev_b32 v5, 3, v5
    v_lshl_add_u32 v5, v2, 1, v5
    s_mul_i32 s43, s3, 1152
    s_lshl_b32 s70, s4, 5
    s_add_u32 s70, s70, s43
    s_lshl2_add_u32 s43, s3, 160960
    v_mov_b32 v6, s43
    ds_read_b32 v12, v6
    v_mov_b32 v28, s68
    v_mov_b32 v29, s68
    v_mov_b32 v30, s68
    v_mov_b32 v31, s68
    s_mov_b32 s44, s36
    s_mov_b32 s45, s37
    s_mov_b32 s46, 4608
    s_mov_b32 s67, 0
    s_mov_b64 s[72:73], -1
    v_mov_b32 v24, s68
    v_mov_b32 v25, s68
    v_mov_b32 v26, s68
    v_mov_b32 v27, s68
    s_cmp_ge_u32 s4, 32
    s_cselect_b32 s16, 0xff0ff0ff, -1
    s_cselect_b32 s17, 0xf0ff0ff0, -1
    s_cselect_b32 s18, 0x0ff0ff0f, -1
    s_waitcnt vmcnt(0)
    s_barrier
    s_cmp_ge_u32 s42, 3
    s_cbranch_scc1 L_ld_done
    s_cmp_ge_u32 s8, 12
    s_cbranch_scc1 L_ld_done
L_r_retry:
    s_mov_b64 exec, s[72:73]
    buffer_load_dwordx4 v[20:23], v4, s[60:63], s64 offen sc1
    s_and_b64 exec, exec, s[16:17]
    s_cbranch_execz L_r_skip1
    buffer_load_dwordx4 v[24:27], v4, s[60:63], s65 offen sc1
L_r_skip1:
    s_and_b32 exec_lo, s72, s18
    s_mov_b32 exec_hi, 0
    s_cbranch_execz L_r_skip
    buffer_load_dwordx4 v[28:31], v4, s[60:63], s66 offen sc1
L_r_skip:
    s_mov_b64 exec, -1
    s_add_u32 s67, s67, 1
    s_cmp_lt_u32 s67, 300000
    s_waitcnt vmcnt(0) lgkmcnt(0)
    v_bitop3_b32 v32, v20, v21, s68 bitop3:0x7e
    v_bitop3_b32 v33, v22, v23, s68 bitop3:0x7e
    v_bitop3_b32 v34, v24, v25, s68 bitop3:0x7e
    v_bitop3_b32 v35, v26, v27, s68 bitop3:0x7e
    v_bitop3_b32 v36, v28, v29, s68 bitop3:0x7e
    v_bitop3_b32 v37, v30, v31, s68 bitop3:0x7e
    v_or3_b32 v32, v32, v33, v34
    v_or3_b32 v35, v35, v36, v37
    v_or_b32 v7, v32, v35
    v_and_b32 v7, 0xff, v7
    v_cmp_ne_u32 vcc, 0, v7
    s_mov_b64 s[72:73], vcc
    s_cbranch_scc0 L_r_ok
    s_cbranch_vccnz L_r_retry
L_r_ok:
    v_xor_b32 v20, s68, v20
    v_xor_b32 v21, s68, v21
    v_xor_b32 v22, s68, v22
    v_xor_b32 v23, s68, v23
    v_xor_b32 v24, s68, v24
    v_xor_b32 v25, s68, v25
    v_xor_b32 v26, s68, v26
    v_xor_b32 v27, s68, v27
    v_xor_b32 v28, s68, v28
    v_xor_b32 v29, s68, v29
    v_xor_b32 v30, s68, v30
    v_xor_b32 v31, s68, v31
    v_pk_add_f32 v[24:25], v[24:25], v[28:29]
    v_pk_add_f32 v[26:27], v[26:27], v[30:31]
    v_pk_add_f32 v[20:21], v[20:21], v[24:25] neg_lo:[0,1] neg_hi:[0,1]
    v_pk_add_f32 v[22:23], v[22:23], v[26:27] neg_lo:[0,1] neg_hi:[0,1]
    v_pk_fma_f32 v[20:21], v[20:21], v[12:13], v[24:25] op_sel:[0,0,0] op_sel_hi:[1,0,1]
    v_pk_fma_f32 v[22:23], v[22:23], v[12:13], v[26:27] op_sel:[0,0,0] op_sel_hi:[1,0,1]
    s_nop 0
    s_nop 0
    v_permlane32_swap_b32 v20, v22
    v_permlane32_swap_b32 v21, v23
    v_add_f32 v20, v20, v22
    v_add_f32 v21, v21, v23
    s_nop 1
    v_permlane16_swap_b32 v20, v21
    v_add_f32 v20, v20, v21
    s_nop 1
    v_add_f32_dpp v20, v20, v20 row_ror:4 row_mask:0xf bank_mask:0xf
    s_nop 1
    v_add_f32_dpp v20, v20, v20 row_ror:8 row_mask:0xf bank_mask:0xf
    v_cvt_pk_bf16_f32 v20, v20, v20
    s_mov_b32 exec_lo, 0xf000f
    s_mov_b32 exec_hi, 0xf000f
    buffer_store_short v20, v5, s[44:47], s70 offen
    s_or_b32 s4, s4, s3
    s_cbranch_scc1 L_ld_done
    s_mov_b64 exec, 1
    v_mov_b32 v8, 428032
    v_mov_b32 v9, s15
    buffer_store_dword v9, v8, s[60:63], 0 offen
L_ld_done:
    s_endpgm
L_ld_wo:
L_hd_wo:
    v_lshrrev_b32 v4, 3, v0
    v_and_b32 v5, 1, v2
    s_and_b32 s43, s3, 1
    s_lshl_b32 s43, s43, 1
    v_xor_b32 v5, s43, v5
    v_lshlrev_b32 v5, 1, v5
    v_and_b32 v6, 7, v0
    v_xor_b32 v5, v5, v6
    v_lshlrev_b32 v5, 4, v5
    v_and_b32 v6, 3, v4
    v_lshrrev_b32 v4, 2, v4
    v_lshl_add_u32 v4, v4, 4, v6
    v_mul_u32_u24 v6, 1152, v4
    v_add_u32 v8, v6, v5
    s_mul_i32 s70, s8, 294912
    s_mul_i32 s43, s7, 384
    s_add_u32 s70, s70, s43
    s_mul_i32 s43, s3, 4608
    s_add_u32 s70, s70, s43
    s_add_u32 s73, s70, 221184
    s_mov_b32 s44, s24
    s_mov_b32 s45, s25
    s_mov_b32 s46, 4718592
    s_add_u32 m0, s67, 65536
    s_nop 0
    buffer_load_dwordx4 v8, s[44:47], s70 offen nt lds
    s_add_u32 m0, s67, 69632
    s_add_u32 s70, s70, 36864
    buffer_load_dwordx4 v8, s[44:47], s70 offen nt lds
    s_add_u32 m0, s67, 73728
    s_add_u32 s70, s70, 36864
    buffer_load_dwordx4 v8, s[44:47], s70 offen nt lds
    s_lshr_b32 s43, s3, 1
    s_lshl_b32 s43, s43, 2
    v_xor_b32 v7, s43, v2
    v_lshlrev_b32 v7, 1, v7
    v_xor_b32 v7, v7, v3
    v_lshlrev_b32 v7, 4, v7
    s_mov_b32 s52, s20
    s_mov_b32 s53, s21
    s_mov_b32 s54, s50
    s_mov_b32 s55, 0x20000
    s_add_u32 s69, s69, s67
    s_mov_b32 s65, s64
    s_add_u32 s64, s64, 8192
    s_and_b32 s64, s64, 0xffff
    s_lshl_b32 s4, s3, 6
    v_xor_b32 v10, s4, v10
    v_lshl_add_u32 v11, v2, 8, v7
    s_add_u32 m0, s67, 77824
    s_add_u32 s70, s70, 36864
    buffer_load_dwordx4 v8, s[44:47], s70 offen nt lds
    s_add_u32 m0, s67, 81920
    s_add_u32 s70, s70, 36864
    buffer_load_dwordx4 v8, s[44:47], s70 offen nt lds
    s_add_u32 m0, s67, 86016
    s_add_u32 s70, s70, 36864
    buffer_load_dwordx4 v8, s[44:47], s70 offen nt lds
    s_waitcnt vmcnt(7)
    s_add_u32 m0, s67, 90112
    s_add_u32 s70, s70, -184192
    buffer_load_dwordx4 v8, s[44:47], s70 offen nt lds
    s_waitcnt vmcnt(7)
    s_add_u32 m0, s67, 94208
    s_add_u32 s70, s70, 36864
    buffer_load_dwordx4 v8, s[44:47], s70 offen nt lds
    s_waitcnt vmcnt(7)
    s_add_u32 m0, s67, 98304
    s_add_u32 s70, s70, 36864
    buffer_load_dwordx4 v8, s[44:47], s70 offen nt lds
    s_waitcnt vmcnt(7)
    s_add_u32 m0, s67, 102400
    s_add_u32 s70, s70, 36864
    buffer_load_dwordx4 v8, s[44:47], s70 offen nt lds
    s_waitcnt vmcnt(7)
    s_add_u32 m0, s67, 106496
    s_add_u32 s70, s70, 36864
    buffer_load_dwordx4 v8, s[44:47], s70 offen nt lds
    s_waitcnt vmcnt(7)
    s_add_u32 m0, s67, 110592
    s_add_u32 s70, s70, 36864
    buffer_load_dwordx4 v8, s[44:47], s70 offen nt lds
    s_waitcnt vmcnt(7)
    s_add_u32 m0, s67, 114688
    s_add_u32 s70, s70, -184192
    buffer_load_dwordx4 v8, s[44:47], s70 offen nt lds
    s_waitcnt vmcnt(7)
    s_add_u32 m0, s67, 118784
    s_add_u32 s70, s70, 36864
    buffer_load_dwordx4 v8, s[44:47], s70 offen nt lds
    s_waitcnt vmcnt(7)
    s_add_u32 m0, s67, 122880
    s_add_u32 s70, s70, 36864
    buffer_load_dwordx4 v8, s[44:47], s70 offen nt lds
    s_waitcnt vmcnt(7)
    s_add_u32 m0, s67, 126976
    s_add_u32 s70, s70, 36864
    buffer_load_dwordx4 v8, s[44:47], s70 offen nt lds
    s_waitcnt vmcnt(7)
    s_add_u32 m0, s67, 131072
    s_add_u32 s70, s70, 36864
    buffer_load_dwordx4 v8, s[44:47], s70 offen nt lds
    s_waitcnt vmcnt(7)
    s_add_u32 m0, s67, 135168
    s_add_u32 s70, s70, 36864
    buffer_load_dwordx4 v8, s[44:47], s70 offen nt lds
    s_waitcnt vmcnt(7)
    s_add_u32 m0, s67, 8192
    s_add_u32 s4, s64, s69
    buffer_load_dwordx4 v10, s[48:51], s4 offen nt lds
    s_add_u32 s64, s64, 4096
    s_waitcnt vmcnt(7)
    s_add_u32 m0, s67, 12288
    s_add_u32 s4, s64, s69
    buffer_load_dwordx4 v10, s[48:51], s4 offen nt lds
    s_add_u32 s64, s64, 4096
    s_and_b32 s64, s64, 0xffff
    s_waitcnt vmcnt(7)
    s_add_u32 m0, s67, 16384
    s_add_u32 s4, s64, s69
    buffer_load_dwordx4 v10, s[48:51], s4 offen nt lds
    s_add_u32 s64, s64, 4096
    s_waitcnt vmcnt(7)
    s_add_u32 m0, s67, 20480
    s_add_u32 s4, s64, s69
    buffer_load_dwordx4 v10, s[48:51], s4 offen nt lds
    s_add_u32 s64, s64, 4096
    s_and_b32 s64, s64, 0xffff
    s_waitcnt vmcnt(7)
    s_add_u32 m0, s67, 24576
    s_add_u32 s4, s64, s69
    buffer_load_dwordx4 v10, s[48:51], s4 offen nt lds
    s_add_u32 s64, s64, 4096
    s_waitcnt vmcnt(7)
    s_add_u32 m0, s67, 28672
    s_add_u32 s4, s64, s69
    buffer_load_dwordx4 v10, s[48:51], s4 offen nt lds
    s_add_u32 s64, s64, 4096
    s_and_b32 s64, s64, 0xffff
    s_waitcnt vmcnt(7)
    s_add_u32 m0, s67, 32768
    s_add_u32 s4, s64, s69
    buffer_load_dwordx4 v10, s[48:51], s4 offen nt lds
    s_add_u32 s64, s64, 4096
    s_waitcnt vmcnt(7)
    s_add_u32 m0, s67, 36864
    s_add_u32 s4, s64, s69
    buffer_load_dwordx4 v10, s[48:51], s4 offen nt lds
    s_add_u32 s64, s64, 4096
    s_and_b32 s64, s64, 0xffff
    s_waitcnt vmcnt(8)
    s_barrier
    s_waitcnt vmcnt(6)
    s_add_u32 m0, s67, 40960
    s_add_u32 s4, s64, s69
    buffer_load_dwordx4 v10, s[48:51], s4 offen nt lds
    s_add_u32 s64, s64, 4096
    s_waitcnt vmcnt(6)
    s_add_u32 m0, s67, 45056
    s_add_u32 s4, s64, s69
    buffer_load_dwordx4 v10, s[48:51], s4 offen nt lds
    s_add_u32 s64, s64, 4096
    s_and_b32 s64, s64, 0xffff
    s_waitcnt vmcnt(6)
    s_add_u32 m0, s67, 49152
    s_add_u32 s4, s64, s69
    buffer_load_dwordx4 v10, s[48:51], s4 offen nt lds
    s_add_u32 s64, s64, 4096
    s_waitcnt vmcnt(6)
    s_add_u32 m0, s67, 53248
    s_add_u32 s4, s64, s69
    buffer_load_dwordx4 v10, s[48:51], s4 offen nt lds
    s_add_u32 s64, s64, 4096
    s_and_b32 s64, s64, 0xffff
    s_waitcnt vmcnt(6)
    s_add_u32 m0, s67, 57344
    s_add_u32 s4, s64, s69
    buffer_load_dwordx4 v10, s[48:51], s4 offen nt lds
    s_add_u32 s64, s64, 4096
    s_waitcnt vmcnt(6)
    s_add_u32 m0, s67, 61440
    s_add_u32 s4, s64, s69
    buffer_load_dwordx4 v10, s[48:51], s4 offen nt lds
    s_barrier
    s_waitcnt vmcnt(6)
    s_add_u32 m0, s67, 131072
    s_nop 0
    buffer_load_dwordx4 v8, s[44:47], s73 offen nt lds
    s_waitcnt vmcnt(6)
    s_add_u32 m0, s67, 135168
    s_add_u32 s73, s73, 36864
    buffer_load_dwordx4 v8, s[44:47], s73 offen nt lds
    s_waitcnt vmcnt(6)
    s_add_u32 m0, s67, 139264
    s_add_u32 s73, s73, -36736
    buffer_load_dwordx4 v8, s[44:47], s73 offen nt lds
    s_waitcnt vmcnt(6)
    s_add_u32 m0, s67, 143360
    s_add_u32 s73, s73, 36864
    buffer_load_dwordx4 v8, s[44:47], s73 offen nt lds
    s_waitcnt vmcnt(6)
    s_add_u32 m0, s67, 147456
    s_add_u32 s73, s73, -36736
    buffer_load_dwordx4 v8, s[44:47], s73 offen nt lds
    s_waitcnt vmcnt(6)
    s_add_u32 m0, s67, 151552
    s_add_u32 s73, s73, 36864
    buffer_load_dwordx4 v8, s[44:47], s73 offen nt lds
    s_waitcnt vmcnt(6)
    s_barrier
    s_waitcnt vmcnt(7)
    s_add_u32 m0, s67, 65536
    s_add_u32 s4, s65, s69
    buffer_load_dwordx4 v11, s[52:55], s4 offen nt lds
    s_add_u32 s65, s65, 4096
    s_waitcnt vmcnt(7)
    s_add_u32 m0, s67, 69632
    s_add_u32 s4, s65, s69
    buffer_load_dwordx4 v11, s[52:55], s4 offen nt lds
    s_add_u32 s65, s65, 4096
    s_and_b32 s65, s65, 0xffff
    s_waitcnt vmcnt(7)
    s_add_u32 m0, s67, 73728
    s_add_u32 s4, s65, s69
    buffer_load_dwordx4 v11, s[52:55], s4 offen nt lds
    s_add_u32 s65, s65, 4096
    s_waitcnt vmcnt(7)
    s_add_u32 m0, s67, 77824
    s_add_u32 s4, s65, s69
    buffer_load_dwordx4 v11, s[52:55], s4 offen nt lds
    s_add_u32 s65, s65, 4096
    s_and_b32 s65, s65, 0xffff
    s_waitcnt vmcnt(7)
    s_add_u32 m0, s67, 81920
    s_add_u32 s4, s65, s69
    buffer_load_dwordx4 v11, s[52:55], s4 offen nt lds
    s_add_u32 s65, s65, 4096
    s_waitcnt vmcnt(7)
    s_add_u32 m0, s67, 86016
    s_add_u32 s4, s65, s69
    buffer_load_dwordx4 v11, s[52:55], s4 offen nt lds
    s_add_u32 s65, s65, 4096
    s_and_b32 s65, s65, 0xffff
    s_waitcnt vmcnt(7)
    s_add_u32 m0, s67, 90112
    s_add_u32 s4, s65, s69
    buffer_load_dwordx4 v11, s[52:55], s4 offen nt lds
    s_add_u32 s65, s65, 4096
    s_waitcnt vmcnt(7)
    s_add_u32 m0, s67, 94208
    s_add_u32 s4, s65, s69
    buffer_load_dwordx4 v11, s[52:55], s4 offen nt lds
    s_add_u32 s65, s65, 4096
    s_and_b32 s65, s65, 0xffff
    s_waitcnt vmcnt(4)
    s_add_u32 m0, s67, 98304
    s_add_u32 s4, s65, s69
    buffer_load_dwordx4 v11, s[52:55], s4 offen nt lds
    s_add_u32 s65, s65, 4096
    s_waitcnt vmcnt(4)
    s_add_u32 m0, s67, 102400
    s_add_u32 s4, s65, s69
    buffer_load_dwordx4 v11, s[52:55], s4 offen nt lds
    s_add_u32 s65, s65, 4096
    s_and_b32 s65, s65, 0xffff
    s_waitcnt vmcnt(4)
    s_add_u32 m0, s67, 106496
    s_add_u32 s4, s65, s69
    buffer_load_dwordx4 v11, s[52:55], s4 offen nt lds
    s_add_u32 s65, s65, 4096
    s_waitcnt vmcnt(4)
    s_add_u32 m0, s67, 110592
    s_add_u32 s4, s65, s69
    buffer_load_dwordx4 v11, s[52:55], s4 offen nt lds
    s_add_u32 s65, s65, 4096
    s_and_b32 s65, s65, 0xffff
    s_waitcnt vmcnt(4)
    s_add_u32 m0, s67, 114688
    s_add_u32 s4, s65, s69
    buffer_load_dwordx4 v11, s[52:55], s4 offen nt lds
    s_add_u32 s65, s65, 4096
    s_waitcnt vmcnt(4)
    s_add_u32 m0, s67, 118784
    s_add_u32 s4, s65, s69
    buffer_load_dwordx4 v11, s[52:55], s4 offen nt lds
    s_add_u32 s65, s65, 4096
    s_and_b32 s65, s65, 0xffff
    s_waitcnt vmcnt(4)
    s_add_u32 m0, s67, 122880
    s_add_u32 s4, s65, s69
    buffer_load_dwordx4 v11, s[52:55], s4 offen nt lds
    s_add_u32 s65, s65, 4096
    s_waitcnt vmcnt(4)
    s_add_u32 m0, s67, 126976
    s_add_u32 s4, s65, s69
    buffer_load_dwordx4 v11, s[52:55], s4 offen nt lds
    s_waitcnt vmcnt(4)
    s_barrier
    s_waitcnt vmcnt(0)
    s_barrier
    s_endpgm
L_compute:
    s_load_dword s68, s[40:41], 428032
    s_sub_u32 s43, s3, 4
    v_lshlrev_b32 v31, 4, v0
    s_mov_b32 s60, s40
    s_mov_b32 s61, s41
    s_mov_b32 s62, 1067264
    s_mov_b32 s63, 0x20000
    s_cmp_eq_u32 s43, 1
    s_cbranch_scc1 L_init_x
    s_cmp_eq_u32 s43, 2
    s_cbranch_scc1 L_init_pref
    s_cmp_lg_u32 s43, 0
    s_cbranch_scc1 L_init_done
    s_getreg_b32 s69, hwreg(HW_REG_XCC_ID, 0, 4)
    s_and_b32 s4, s2, 7
    s_lshl_b32 s4, s4, 7
    s_add_u32 s4, s4, 425984
    s_add_u32 s50, s40, s4
    s_addc_u32 s51, s41, 0
    s_lshl4_add_u32 s5, s6, s7
    s_lshl_b32 s5, s5, 2
    s_lshl_b32 s69, s69, 16
    s_waitcnt lgkmcnt(0)
    s_add_u32 s4, s68, 1
    s_and_b32 s4, s4, 0xffff
    s_or_b32 s69, s69, s4
    v_mov_b32 v4, s5
    v_mov_b32 v5, s69
    s_mov_b64 exec, 1
    global_store_dword v4, v5, s[50:51]
    s_mov_b64 exec, -1
    s_branch L_init_done
L_init_pref:
    s_getpc_b64 s[44:45]
L_pc:
    s_sub_u32 s44, s44, L_pc - gated_mix__sliding_block_cached__glu_gated_reglu__decode_kernel
    s_subb_u32 s45, s45, 0
    s_min_u32 s4, s7, 8
    s_lshl_b32 s4, s4, 10
    s_add_u32 s4, s4, 8192
    v_add_u32 v5, s4, v31
    v_min_u32 v6, L_code_end - gated_mix__sliding_block_cached__glu_gated_reglu__decode_kernel - 16, v5
    global_load_dwordx4 v[36:39], v6, s[44:45]
    s_branch L_init_done
L_init_x:
    s_cmp_lt_u32 s7, 3
    s_cbranch_scc1 L_init_done
    s_mov_b32 s44, s16
    s_mov_b32 s45, s17
    s_mov_b32 s46, 4608
    s_mov_b32 s47, 0x20000
    s_mov_b32 m0, 139264
    s_mov_b32 s48, s34
    s_mov_b32 s49, s35
    s_mov_b32 s50, 1152
    s_mov_b32 s51, 0x20000
    buffer_load_dwordx4 v31, s[44:47], 0 offen offset:0 lds
    buffer_load_dwordx4 v31, s[44:47], 0 offen offset:1024 lds
    buffer_load_dwordx4 v31, s[44:47], 0 offen offset:2048 lds
    buffer_load_dwordx4 v31, s[44:47], 0 offen offset:3072 lds
    s_mov_b32 m0, 143360
    v_add_u32 v5, 4096, v31
    buffer_load_dwordx4 v5, s[44:47], 0 offen lds
    s_sub_u32 s4, s7, 3
    s_cmp_ge_u32 s4, 3
    s_cbranch_scc1 L_init_done
    s_cmp_ge_u32 s8, 12
    s_cbranch_scc1 L_init_done
    v_lshlrev_b32 v5, 4, v3
    buffer_load_dwordx4 v[40:43], v5, s[48:51], 0 offen offset:0
    buffer_load_dwordx4 v[44:47], v5, s[48:51], 0 offen offset:256
    buffer_load_dwordx4 v[48:51], v5, s[48:51], 0 offen offset:512
    buffer_load_dwordx4 v[52:55], v5, s[48:51], 0 offen offset:768
    buffer_load_dwordx4 v[56:59], v5, s[48:51], 0 offen offset:1024
    v_mul_u32_u24 v6, 1152, v2
    v_add_u32 v6, 139264, v6
    v_and_b32 v7, 0x70, v5
    v_add_u32 v7, v7, v6
    v_add_u32 v6, v6, v5
    v_mov_b32 v36, 0
    v_mov_b32 v37, 0x3f803f80
    s_waitcnt vmcnt(0)
    ds_read_b128 v[60:63], v6 offset:0
    ds_read_b128 v[64:67], v6 offset:256
    ds_read_b128 v[68:71], v6 offset:512
    ds_read_b128 v[72:75], v6 offset:768
    ds_read_b128 v[76:79], v7 offset:1024
    s_waitcnt lgkmcnt(0)
    v_lshlrev_b32 v4, 16, v40
    v_and_b32 v5, 0xffff0000, v40
    v_lshlrev_b32 v6, 16, v60
    v_and_b32 v7, 0xffff0000, v60
    v_pk_mul_f32 v[4:5], v[4:5], v[6:7]
    v_cvt_pk_bf16_f32 v4, v4, v5
    v_dot2_f32_bf16 v36, v4, v37, v36
    v_lshlrev_b32 v4, 16, v41
    v_and_b32 v5, 0xffff0000, v41
    v_lshlrev_b32 v6, 16, v61
    v_and_b32 v7, 0xffff0000, v61
    v_pk_mul_f32 v[4:5], v[4:5], v[6:7]
    v_cvt_pk_bf16_f32 v4, v4, v5
    v_dot2_f32_bf16 v36, v4, v37, v36
    v_lshlrev_b32 v4, 16, v42
    v_and_b32 v5, 0xffff0000, v42
    v_lshlrev_b32 v6, 16, v62
    v_and_b32 v7, 0xffff0000, v62
    v_pk_mul_f32 v[4:5], v[4:5], v[6:7]
    v_cvt_pk_bf16_f32 v4, v4, v5
    v_dot2_f32_bf16 v36, v4, v37, v36
    v_lshlrev_b32 v4, 16, v43
    v_and_b32 v5, 0xffff0000, v43
    v_lshlrev_b32 v6, 16, v63
    v_and_b32 v7, 0xffff0000, v63
    v_pk_mul_f32 v[4:5], v[4:5], v[6:7]
    v_cvt_pk_bf16_f32 v4, v4, v5
    v_dot2_f32_bf16 v36, v4, v37, v36
    v_lshlrev_b32 v4, 16, v44
    v_and_b32 v5, 0xffff0000, v44
    v_lshlrev_b32 v6, 16, v64
    v_and_b32 v7, 0xffff0000, v64
    v_pk_mul_f32 v[4:5], v[4:5], v[6:7]
    v_cvt_pk_bf16_f32 v4, v4, v5
    v_dot2_f32_bf16 v36, v4, v37, v36
    v_lshlrev_b32 v4, 16, v45
    v_and_b32 v5, 0xffff0000, v45
    v_lshlrev_b32 v6, 16, v65
    v_and_b32 v7, 0xffff0000, v65
    v_pk_mul_f32 v[4:5], v[4:5], v[6:7]
    v_cvt_pk_bf16_f32 v4, v4, v5
    v_dot2_f32_bf16 v36, v4, v37, v36
    v_lshlrev_b32 v4, 16, v46
    v_and_b32 v5, 0xffff0000, v46
    v_lshlrev_b32 v6, 16, v66
    v_and_b32 v7, 0xffff0000, v66
    v_pk_mul_f32 v[4:5], v[4:5], v[6:7]
    v_cvt_pk_bf16_f32 v4, v4, v5
    v_dot2_f32_bf16 v36, v4, v37, v36
    v_lshlrev_b32 v4, 16, v47
    v_and_b32 v5, 0xffff0000, v47
    v_lshlrev_b32 v6, 16, v67
    v_and_b32 v7, 0xffff0000, v67
    v_pk_mul_f32 v[4:5], v[4:5], v[6:7]
    v_cvt_pk_bf16_f32 v4, v4, v5
    v_dot2_f32_bf16 v36, v4, v37, v36
    v_lshlrev_b32 v4, 16, v48
    v_and_b32 v5, 0xffff0000, v48
    v_lshlrev_b32 v6, 16, v68
    v_and_b32 v7, 0xffff0000, v68
    v_pk_mul_f32 v[4:5], v[4:5], v[6:7]
    v_cvt_pk_bf16_f32 v4, v4, v5
    v_dot2_f32_bf16 v36, v4, v37, v36
    v_lshlrev_b32 v4, 16, v49
    v_and_b32 v5, 0xffff0000, v49
    v_lshlrev_b32 v6, 16, v69
    v_and_b32 v7, 0xffff0000, v69
    v_pk_mul_f32 v[4:5], v[4:5], v[6:7]
    v_cvt_pk_bf16_f32 v4, v4, v5
    v_dot2_f32_bf16 v36, v4, v37, v36
    v_lshlrev_b32 v4, 16, v50
    v_and_b32 v5, 0xffff0000, v50
    v_lshlrev_b32 v6, 16, v70
    v_and_b32 v7, 0xffff0000, v70
    v_pk_mul_f32 v[4:5], v[4:5], v[6:7]
    v_cvt_pk_bf16_f32 v4, v4, v5
    v_dot2_f32_bf16 v36, v4, v37, v36
    v_lshlrev_b32 v4, 16, v51
    v_and_b32 v5, 0xffff0000, v51
    v_lshlrev_b32 v6, 16, v71
    v_and_b32 v7, 0xffff0000, v71
    v_pk_mul_f32 v[4:5], v[4:5], v[6:7]
    v_cvt_pk_bf16_f32 v4, v4, v5
    v_dot2_f32_bf16 v36, v4, v37, v36
    v_lshlrev_b32 v4, 16, v52
    v_and_b32 v5, 0xffff0000, v52
    v_lshlrev_b32 v6, 16, v72
    v_and_b32 v7, 0xffff0000, v72
    v_pk_mul_f32 v[4:5], v[4:5], v[6:7]
    v_cvt_pk_bf16_f32 v4, v4, v5
    v_dot2_f32_bf16 v36, v4, v37, v36
    v_lshlrev_b32 v4, 16, v53
    v_and_b32 v5, 0xffff0000, v53
    v_lshlrev_b32 v6, 16, v73
    v_and_b32 v7, 0xffff0000, v73
    v_pk_mul_f32 v[4:5], v[4:5], v[6:7]
    v_cvt_pk_bf16_f32 v4, v4, v5
    v_dot2_f32_bf16 v36, v4, v37, v36
    v_lshlrev_b32 v4, 16, v54
    v_and_b32 v5, 0xffff0000, v54
    v_lshlrev_b32 v6, 16, v74
    v_and_b32 v7, 0xffff0000, v74
    v_pk_mul_f32 v[4:5], v[4:5], v[6:7]
    v_cvt_pk_bf16_f32 v4, v4, v5
    v_dot2_f32_bf16 v36, v4, v37, v36
    v_lshlrev_b32 v4, 16, v55
    v_and_b32 v5, 0xffff0000, v55
    v_lshlrev_b32 v6, 16, v75
    v_and_b32 v7, 0xffff0000, v75
    v_pk_mul_f32 v[4:5], v[4:5], v[6:7]
    v_cvt_pk_bf16_f32 v4, v4, v5
    v_dot2_f32_bf16 v36, v4, v37, v36
    v_lshlrev_b32 v4, 16, v56
    v_and_b32 v5, 0xffff0000, v56
    v_lshlrev_b32 v6, 16, v76
    v_and_b32 v7, 0xffff0000, v76
    v_pk_mul_f32 v[4:5], v[4:5], v[6:7]
    v_cvt_pk_bf16_f32 v4, v4, v5
    v_dot2_f32_bf16 v36, v4, v37, v36
    v_lshlrev_b32 v4, 16, v57
    v_and_b32 v5, 0xffff0000, v57
    v_lshlrev_b32 v6, 16, v77
    v_and_b32 v7, 0xffff0000, v77
    v_pk_mul_f32 v[4:5], v[4:5], v[6:7]
    v_cvt_pk_bf16_f32 v4, v4, v5
    v_dot2_f32_bf16 v36, v4, v37, v36
    v_lshlrev_b32 v4, 16, v58
    v_and_b32 v5, 0xffff0000, v58
    v_lshlrev_b32 v6, 16, v78
    v_and_b32 v7, 0xffff0000, v78
    v_pk_mul_f32 v[4:5], v[4:5], v[6:7]
    v_cvt_pk_bf16_f32 v4, v4, v5
    v_dot2_f32_bf16 v36, v4, v37, v36
    v_lshlrev_b32 v4, 16, v59
    v_and_b32 v5, 0xffff0000, v59
    v_lshlrev_b32 v6, 16, v79
    v_and_b32 v7, 0xffff0000, v79
    v_pk_mul_f32 v[4:5], v[4:5], v[6:7]
    v_cvt_pk_bf16_f32 v4, v4, v5
    v_dot2_f32_bf16 v36, v4, v37, v36
    s_nop 3
    v_add_f32_dpp v36, v36, v36 row_ror:1 row_mask:0xf bank_mask:0xf
    s_nop 1
    v_add_f32_dpp v36, v36, v36 row_ror:2 row_mask:0xf bank_mask:0xf
    s_nop 1
    v_add_f32_dpp v36, v36, v36 row_ror:4 row_mask:0xf bank_mask:0xf
    s_nop 1
    v_add_f32_dpp v36, v36, v36 row_ror:8 row_mask:0xf bank_mask:0xf
    v_cvt_pk_bf16_f32 v36, v36, v36
    v_and_b32 v36, 0xffff0000, v36
    v_mul_f32 v36, 0xbfb8aa3b, v36
    v_exp_f32 v36, v36
    v_lshlrev_b32 v5, 2, v2
    v_add_f32 v36, 1.0, v36
    v_rcp_f32 v36, v36
    v_add_u32 v5, 160960, v5
    v_cvt_pk_bf16_f32 v36, v36, v36
    v_and_b32 v36, 0xffff0000, v36
    v_cmp_eq_u32 vcc, 0, v3
    s_nop 1
    s_mov_b64 exec, vcc
    ds_write_b32 v5, v36
    s_mov_b64 exec, -1
L_init_done:
    s_cmp_lt_u32 s7, 7
    s_cbranch_scc1 L_u_q
    s_mul_i32 s12, s6, 9
    s_add_u32 s12, s12, s7
    s_sub_u32 s12, s12, 1
    s_lshr_b32 s13, s12, 3
    s_and_b32 s14, s12, 7
    s_mov_b32 s54, 0
    s_mul_i32 s12, s13, 24
    s_and_b32 s5, s2, 7
    s_mul_i32 s4, s5, 72
    s_add_u32 s12, s12, s4
    s_mul_i32 s4, s5, 3
    s_add_u32 s13, s13, s4
    s_branch L_u_done
L_u_q:
    s_lshl2_add_u32 s12, s6, s7
    s_sub_u32 s12, s12, 3
    s_cmp_lt_u32 s12, 2
    s_cselect_b32 s54, 1, 0
    s_cselect_b32 s13, s12, 0
    s_cselect_b32 s14, 10, s12
    s_sub_u32 s14, s14, 2
    s_mul_i32 s12, s13, 36
    s_and_b32 s5, s2, 7
    s_mul_i32 s4, s5, 72
    s_add_u32 s12, s12, s4
    s_mul_i32 s4, s5, 3
    s_add_u32 s13, s13, s4
L_u_done:
    s_lshl4_add_u32 s11, s8, s7
    s_and_b32 s58, s42, 1
    s_lshl1_add_u32 s64, s6, s58
    s_mul_i32 s64, s64, 73728
    s_add_u32 s64, s64, 131072
    s_lshl_b32 s4, s58, 16
    s_cmp_lt_u32 s7, 7
    s_cselect_b32 s64, s4, s64
    s_lshr_b32 s4, s42, 1
    s_lshl_b32 s4, s4, 11
    s_add_u32 s64, s64, s4
    s_lshl_b32 s4, s43, 9
    s_add_u32 s64, s64, s4
    s_lshl_b32 s4, s43, 8
    s_lshl_b32 s74, s11, 10
    s_add_u32 s74, s74, s4
    s_add_u32 s74, s74, 436480
    s_lshl_b32 s75, s11, 5
    s_add_u32 s75, s75, 428288
    s_mul_i32 s4, s7, 12
    s_lshl_b32 s5, s14, 2
    s_add_u32 s65, s13, 16
    s_cmp_lt_u32 s7, 3
    s_cselect_b32 s4, s4, s5
    s_cselect_b32 s65, s8, s65
    s_add_u32 s4, s4, s43
    s_mul_i32 s4, s4, 10240
    s_lshl_b32 s65, s65, 8
    s_add_u32 s65, s65, s4
    s_add_u32 s65, s65, 698624
    s_lshl_b32 s66, s8, 12
    s_lshl_b32 s4, s9, 6
    s_add_u32 s66, s66, s4
    s_add_u32 s67, s66, 65536
    s_mov_b32 s55, 0x07060302
    v_bfe_u32 v5, v0, 2, 2
    v_and_b32 v6, 3, v0
    v_lshrrev_b32 v7, 1, v5
    v_and_b32 v4, 1, v2
    v_lshlrev_b32 v1, 1, v4
    v_xor_b32 v7, v7, v1
    v_xor_b32 v7, s43, v7
    v_lshlrev_b32 v7, 5, v7
    v_lshl_add_u32 v7, v5, 7, v7
    v_lshl_add_u32 v7, v6, 3, v7
    v_lshl_add_u32 v7, v2, 10, v7
    v_add_u32 v8, 65536, v7
    v_add_u32 v9, 131072, v7
    v_lshl_add_u32 v7, v4, 2, v5
    s_lshl_b32 s4, s43, 1
    v_xor_b32 v7, s4, v7
    v_lshlrev_b32 v7, 5, v7
    v_lshl_add_u32 v1, v2, 3, v5
    v_lshl_add_u32 v7, v1, 8, v7
    v_lshl_add_u32 v7, v6, 3, v7
    v_add_u32 v10, 65536, v7
    v_xor_b32 v11, 32, v10
    v_add_u32 v145, 0x10000, v10
    v_add_u32 v146, 0x10000, v11
    v_and_b32 v1, 1, v3
    v_lshlrev_b32 v7, 4, v1
    v_add_u32 v12, 160896, v7
    s_lshl_b32 s4, s43, 2
    v_add_u32 v13, s4, v12
    v_mov_b32 v32, -1
    s_mov_b64 exec, 3
    ds_write2_b32 v13, v32, v32 offset1:8
    s_mov_b64 exec, -1
    v_lshlrev_b32 v7, 6, v3
    v_lshl_add_u32 v15, v2, 4, v7
    v_lshrrev_b32 v7, 2, v0
    v_lshlrev_b32 v7, 8, v7
    v_lshl_add_u32 v16, v6, 4, v7
    v_lshrrev_b32 v7, 5, v0
    v_lshlrev_b32 v7, 6, v7
    v_lshl_add_u32 v7, v0, 3, v7
    v_add_u32 v14, 160992, v7
    v_mul_u32_u24 v7, 320, v1
    v_lshl_add_u32 v7, v2, 4, v7
    v_add_u32 v27, 160992, v7
    v_xor_b32 v7, v3, v2
    v_lshlrev_b32 v7, 4, v7
    v_lshl_add_u32 v7, v3, 8, v7
    s_lshl_b32 s4, s43, 14
    v_add_u32 v17, s4, v7
    v_xor_b32 v18, 64, v17
    v_xor_b32 v19, 0x80, v17
    v_xor_b32 v20, 0xc0, v17
    v_mul_u32_u24 v7, 576, v1
    v_add_u32 v7, 159744, v7
    v_lshl_add_u32 v22, v2, 4, v7
    v_lshl_add_u32 v7, v2, 3, v7
    s_lshl_b32 s4, s43, 7
    v_add_u32 v21, s4, v7
    v_mul_u32_u24 v7, 1152, v6
    v_lshl_add_u32 v7, v2, 4, v7
    s_mul_i32 s4, s58, 576
    s_add_u32 s4, s4, 139264
    v_add_u32 v26, s4, v7
    v_mov_b32 v144, 0xffffff00
    v_cmp_gt_u32 s[52:53], 2, v3
    v_cmp_gt_u32 s[56:57], 4, v3
    s_cmp_lt_u32 s7, 3
    s_cbranch_scc1 L_addr_wo
    s_lshr_b32 s5, s12, 1
    s_lshl1_add_u32 s4, s54, 3
    s_mul_i32 s4, s4, s43
    v_add_u32 v7, s4, v2
    v_min_u32 v7, 17, v7
    v_add_u32 v7, s5, v7
    v_lshlrev_b32 v7, 8, v7
    v_lshl_add_u32 v23, v3, 4, v7
    v_lshlrev_b32 v7, 7, v2
    v_bfe_u32 v1, v0, 1, 1
    v_lshl_add_u32 v7, v1, 6, v7
    v_lshl_add_u32 v7, v5, 4, v7
    v_and_b32 v1, 1, v0
    v_lshl_add_u32 v7, v1, 3, v7
    s_lshl_b32 s5, s4, 7
    s_add_u32 s5, s5, 49152
    v_add_u32 v24, s5, v7
    v_lshlrev_b32 v7, 6, v2
    v_lshl_add_u32 v7, v6, 4, v7
    v_add_u32 v25, 49152, v7
    v_add_u32 v8, -65536, v8
    s_mov_b32 s72, 131072
    s_mov_b32 s73, 204800
    s_mov_b32 s48, 278528
    s_mov_b32 s49, 352256
    s_branch L_addr_done
L_addr_wo:
    v_bfe_u32 v1, v0, 2, 1
    v_lshlrev_b32 v7, 8, v1
    v_lshl_add_u32 v7, v2, 6, v7
    v_lshl_add_u32 v7, v6, 4, v7
    v_bfe_u32 v5, v0, 3, 1
    v_lshl_add_u32 v7, v5, 3, v7
    s_mul_i32 s4, s43, 576
    v_add_u32 v24, s4, v7
    v_mul_u32_u24 v7, 576, v6
    v_lshl_add_u32 v25, v2, 4, v7
    v_lshlrev_b32 v7, 5, v6
    v_lshl_add_u32 v23, v1, 4, v7
    s_lshl_b32 s72, s8, 9
    s_lshl_b32 s5, s43, 7
    s_add_u32 s72, s72, s5
    s_add_u32 s72, s72, 428288
    s_lshl_b32 s4, s8, 14
    s_lshl_b32 s5, s43, 12
    s_add_u32 s4, s4, s5
    s_add_u32 s73, s4, 436480
L_addr_done:
    s_waitcnt vmcnt(0) lgkmcnt(0)
    s_add_u32 s68, s68, 1
    s_and_b32 s70, s68, 0xff
    s_and_b32 s68, s68, 0xffff
    s_mov_b32 s71, 0
    v_mov_b32 v160, s70
    v_mov_b32 v161, s70
    v_mov_b32 v162, s70
    v_mov_b32 v163, s70
    v_mov_b32 v164, s70
    v_mov_b32 v165, s70
    v_mov_b32 v166, s70
    v_mov_b32 v167, s70
    v_mov_b32 v168, s70
    v_mov_b32 v169, s70
    v_mov_b32 v170, s70
    v_mov_b32 v171, s70
    v_mov_b32 v172, s70
    v_mov_b32 v173, s70
    v_mov_b32 v174, s70
    v_mov_b32 v175, s70
    v_mov_b32 v176, s70
    v_mov_b32 v177, s70
    v_mov_b32 v178, s70
    v_mov_b32 v179, s70
    v_mov_b32 v180, s70
    v_mov_b32 v181, s70
    v_mov_b32 v182, s70
    v_mov_b32 v183, s70
    v_mov_b32 v184, s70
    v_mov_b32 v185, s70
    v_mov_b32 v186, s70
    v_mov_b32 v187, s70
    v_mov_b32 v188, s70
    v_mov_b32 v189, s70
    v_mov_b32 v190, s70
    v_mov_b32 v191, s70
    s_cmp_lg_u32 s43, 0
    s_cbranch_scc1 L_x_skip
    s_mov_b32 exec_hi, 0
    s_mov_b32 exec_lo, 0xffffffff
    v_lshlrev_b32 v4, 2, v0
    s_mov_b32 s5, 0
    s_waitcnt vmcnt(0)
L_x_retry:
    global_load_dword v5, v4, s[50:51] sc1
    s_waitcnt vmcnt(0)
    v_cmp_ne_u32 vcc, s69, v5
    s_mov_b32 s4, 1
    s_cbranch_vccz L_x_done
    s_mov_b32 s4, 0
    s_add_u32 s5, s5, 1
    s_cmp_lt_u32 s5, 3
    s_cbranch_scc1 L_x_retry
L_x_done:
    s_mov_b64 exec, 1
    v_mov_b32 v4, 160976
    v_mov_b32 v5, s4
    ds_write_b32 v4, v5
    s_mov_b64 exec, -1
    s_waitcnt lgkmcnt(0)
L_x_skip:
    s_barrier
    v_mov_b32 v4, 160976
    ds_read_b32 v147, v4
    s_cmp_lt_u32 s7, 3
    s_cbranch_scc1 L_c1_wo
    ds_read_b64_tr_b16 v[40:41], v10 offset:0
    ds_read_b64_tr_b16 v[42:43], v10 offset:1024
    ds_read_b128 v[48:51], v26 offset:0
    ds_read_b64_tr_b16 v[44:45], v11 offset:0
    ds_read_b64_tr_b16 v[46:47], v11 offset:1024
    ds_read_b64_tr_b16 v[52:53], v10 offset:8192
    ds_read_b64_tr_b16 v[54:55], v10 offset:9216
    ds_read_b128 v[60:63], v26 offset:64
    ds_read_b64_tr_b16 v[56:57], v11 offset:8192
    ds_read_b64_tr_b16 v[58:59], v11 offset:9216
    ds_read_b64_tr_b16 v[64:65], v10 offset:16384
    ds_read_b64_tr_b16 v[66:67], v10 offset:17408
    ds_read_b128 v[72:75], v26 offset:128
    ds_read_b64_tr_b16 v[68:69], v11 offset:16384
    ds_read_b64_tr_b16 v[70:71], v11 offset:17408
    s_waitcnt lgkmcnt(10)
    v_mfma_f32_16x16x32_bf16 v[32:35], v[40:43], v[48:51], 0
    v_mfma_f32_16x16x32_bf16 v[36:39], v[44:47], v[48:51], 0
    ds_read_b64_tr_b16 v[40:41], v10 offset:24576
    ds_read_b64_tr_b16 v[42:43], v10 offset:25600
    ds_read_b128 v[48:51], v26 offset:192
    ds_read_b64_tr_b16 v[44:45], v11 offset:24576
    ds_read_b64_tr_b16 v[46:47], v11 offset:25600
    s_waitcnt lgkmcnt(10)
    v_mfma_f32_16x16x32_bf16 v[32:35], v[52:55], v[60:63], v[32:35]
    v_mfma_f32_16x16x32_bf16 v[36:39], v[56:59], v[60:63], v[36:39]
    ds_read_b64_tr_b16 v[52:53], v10 offset:32768
    ds_read_b64_tr_b16 v[54:55], v10 offset:33792
    ds_read_b128 v[60:63], v26 offset:256
    ds_read_b64_tr_b16 v[56:57], v11 offset:32768
    ds_read_b64_tr_b16 v[58:59], v11 offset:33792
    s_waitcnt lgkmcnt(10)
    v_mfma_f32_16x16x32_bf16 v[32:35], v[64:67], v[72:75], v[32:35]
    v_mfma_f32_16x16x32_bf16 v[36:39], v[68:71], v[72:75], v[36:39]
    ds_read_b64_tr_b16 v[64:65], v10 offset:40960
    ds_read_b64_tr_b16 v[66:67], v10 offset:41984
    ds_read_b128 v[72:75], v26 offset:320
    ds_read_b64_tr_b16 v[68:69], v11 offset:40960
    ds_read_b64_tr_b16 v[70:71], v11 offset:41984
    s_waitcnt lgkmcnt(10)
    v_mfma_f32_16x16x32_bf16 v[32:35], v[40:43], v[48:51], v[32:35]
    v_mfma_f32_16x16x32_bf16 v[36:39], v[44:47], v[48:51], v[36:39]
    ds_read_b64_tr_b16 v[40:41], v10 offset:49152
    ds_read_b64_tr_b16 v[42:43], v10 offset:50176
    ds_read_b128 v[48:51], v26 offset:384
    ds_read_b64_tr_b16 v[44:45], v11 offset:49152
    ds_read_b64_tr_b16 v[46:47], v11 offset:50176
    s_waitcnt lgkmcnt(10)
    v_mfma_f32_16x16x32_bf16 v[32:35], v[52:55], v[60:63], v[32:35]
    v_mfma_f32_16x16x32_bf16 v[36:39], v[56:59], v[60:63], v[36:39]
    ds_read_b64_tr_b16 v[52:53], v10 offset:57344
    ds_read_b64_tr_b16 v[54:55], v10 offset:58368
    ds_read_b128 v[60:63], v26 offset:448
    ds_read_b64_tr_b16 v[56:57], v11 offset:57344
    ds_read_b64_tr_b16 v[58:59], v11 offset:58368
    s_waitcnt lgkmcnt(10)
    v_mfma_f32_16x16x32_bf16 v[32:35], v[64:67], v[72:75], v[32:35]
    v_mfma_f32_16x16x32_bf16 v[36:39], v[68:71], v[72:75], v[36:39]
    ds_read_b64_tr_b16 v[64:65], v145 offset:0
    ds_read_b64_tr_b16 v[66:67], v145 offset:1024
    ds_read_b128 v[72:75], v26 offset:512
    ds_read_b64_tr_b16 v[68:69], v146 offset:0
    ds_read_b64_tr_b16 v[70:71], v146 offset:1024
    s_waitcnt lgkmcnt(10)
    v_mfma_f32_16x16x32_bf16 v[32:35], v[40:43], v[48:51], v[32:35]
    v_mfma_f32_16x16x32_bf16 v[36:39], v[44:47], v[48:51], v[36:39]
    s_waitcnt lgkmcnt(5)
    v_mfma_f32_16x16x32_bf16 v[32:35], v[52:55], v[60:63], v[32:35]
    v_mfma_f32_16x16x32_bf16 v[36:39], v[56:59], v[60:63], v[36:39]
    s_waitcnt lgkmcnt(0)
    v_mfma_f32_16x16x32_bf16 v[32:35], v[64:67], v[72:75], v[32:35]
    v_mfma_f32_16x16x32_bf16 v[36:39], v[68:71], v[72:75], v[36:39]
    v_readfirstlane_b32 s71, v147
    s_mov_b64 exec, s[56:57]
    s_nop 5
    v_add_u32 v32, 0x80, v32
    v_add_u32 v33, 0x80, v33
    v_add_u32 v34, 0x80, v34
    v_add_u32 v35, 0x80, v35
    v_add_u32 v36, 0x80, v36
    v_add_u32 v37, 0x80, v37
    v_add_u32 v38, 0x80, v38
    v_add_u32 v39, 0x80, v39
    v_bfi_b32 v32, v144, v32, s70
    v_bfi_b32 v33, v144, v33, s70
    v_bfi_b32 v34, v144, v34, s70
    v_bfi_b32 v35, v144, v35, s70
    v_bfi_b32 v36, v144, v36, s70
    v_bfi_b32 v37, v144, v37, s70
    v_bfi_b32 v38, v144, v38, s70
    v_bfi_b32 v39, v144, v39, s70
    s_and_b32 s4, s2, 1
    s_lshl_b32 s4, s4, 3
    s_xor_b32 s4, s4, 15
    s_cmp_eq_u32 s7, s4
    s_cselect_b32 s4, 0, s71
    s_cmp_lg_u32 s4, 0
    s_cbranch_scc0 L_p1_far
    buffer_store_dwordx4 v[32:35], v15, s[60:63], s64 offen
    buffer_store_dwordx4 v[36:39], v15, s[60:63], s64 offen offset:256
L_p1_pub:
    s_mov_b64 exec, -1
    s_branch L_c1_done
L_c1_wo:
    ds_read_b64_tr_b16 v[160:161], v8 offset:0
    ds_read_b64_tr_b16 v[162:163], v8 offset:512
    ds_read_b64_tr_b16 v[164:165], v8 offset:4096
    ds_read_b64_tr_b16 v[166:167], v8 offset:4608
    ds_read_b64_tr_b16 v[168:169], v8 offset:8192
    ds_read_b64_tr_b16 v[170:171], v8 offset:8704
    ds_read_b64_tr_b16 v[172:173], v8 offset:12288
    ds_read_b64_tr_b16 v[174:175], v8 offset:12800
    ds_read_b64_tr_b16 v[176:177], v8 offset:16384
    ds_read_b64_tr_b16 v[178:179], v8 offset:16896
    ds_read_b64_tr_b16 v[180:181], v8 offset:20480
    ds_read_b64_tr_b16 v[182:183], v8 offset:20992
    ds_read_b64_tr_b16 v[192:193], v8 offset:24576
    ds_read_b64_tr_b16 v[194:195], v8 offset:25088
    ds_read_b64_tr_b16 v[196:197], v8 offset:28672
    ds_read_b64_tr_b16 v[198:199], v8 offset:29184
    ds_read_b64_tr_b16 v[200:201], v8 offset:32768
    ds_read_b64_tr_b16 v[202:203], v8 offset:33280
    ds_read_b64_tr_b16 v[204:205], v8 offset:36864
    ds_read_b64_tr_b16 v[206:207], v8 offset:37376
    ds_read_b64_tr_b16 v[208:209], v8 offset:40960
    ds_read_b64_tr_b16 v[210:211], v8 offset:41472
    ds_read_b64_tr_b16 v[212:213], v8 offset:45056
    ds_read_b64_tr_b16 v[214:215], v8 offset:45568
    ds_read_b64_tr_b16 v[224:225], v8 offset:49152
    ds_read_b64_tr_b16 v[226:227], v8 offset:49664
    ds_read_b64_tr_b16 v[228:229], v8 offset:53248
    ds_read_b64_tr_b16 v[230:231], v8 offset:53760
    ds_read_b64_tr_b16 v[232:233], v8 offset:57344
    ds_read_b64_tr_b16 v[234:235], v8 offset:57856
    ds_read_b64_tr_b16 v[236:237], v8 offset:61440
    ds_read_b64_tr_b16 v[238:239], v8 offset:61952
    ds_read_b64_tr_b16 v[240:241], v9 offset:0
    ds_read_b64_tr_b16 v[242:243], v9 offset:512
    ds_read_b64_tr_b16 v[244:245], v9 offset:4096
    ds_read_b64_tr_b16 v[246:247], v9 offset:4608
    buffer_load_dwordx4 v[152:155], v23, s[60:63], s72 offen sc1
    buffer_load_dwordx4 v[112:115], v31, s[60:63], s73 offen offset:0 sc1
    buffer_load_dwordx4 v[116:119], v31, s[60:63], s73 offen offset:1024 sc1
    buffer_load_dwordx4 v[120:123], v31, s[60:63], s73 offen offset:2048 sc1
    buffer_load_dwordx4 v[124:127], v31, s[60:63], s73 offen offset:3072 sc1
    s_waitcnt lgkmcnt(0)
    v_readfirstlane_b32 s71, v147
L_c1_done:
    s_barrier
    buffer_load_dwordx4 v[128:131], v16, s[60:63], s66 offen sc1
    buffer_load_dwordx4 v[132:135], v16, s[60:63], s67 offen sc1
    s_barrier
    ds_read_b128 v[48:51], v17 offset:0
    ds_read_b128 v[52:55], v18 offset:0
    ds_read_b128 v[56:59], v19 offset:0
    ds_read_b128 v[60:63], v20 offset:0
    ds_read_b128 v[64:67], v17 offset:4096
    ds_read_b128 v[68:71], v18 offset:4096
    ds_read_b128 v[72:75], v19 offset:4096
    ds_read_b128 v[76:79], v20 offset:4096
    ds_read_b128 v[80:83], v17 offset:8192
    ds_read_b128 v[84:87], v18 offset:8192
    ds_read_b128 v[88:91], v19 offset:8192
    ds_read_b128 v[92:95], v20 offset:8192
    s_waitcnt lgkmcnt(4)
    ds_read_b128 v[96:99], v17 offset:12288
    ds_read_b128 v[100:103], v18 offset:12288
    ds_read_b128 v[104:107], v19 offset:12288
    ds_read_b128 v[108:111], v20 offset:12288
    s_mov_b32 s5, 0
    s_cmp_eq_u32 s5, 0
    s_branch L_q_check
L_q_retry:
    buffer_load_dwordx4 v[128:131], v16, s[60:63], s66 offen sc1
    buffer_load_dwordx4 v[132:135], v16, s[60:63], s67 offen sc1
    s_add_u32 s5, s5, 1
    s_cmp_lt_u32 s5, 300000
L_q_check:
    s_waitcnt vmcnt(0)
    v_xor_b32 v128, s70, v128
    v_xor_b32 v129, s70, v129
    v_xor_b32 v130, s70, v130
    v_xor_b32 v131, s70, v131
    v_xor_b32 v132, s70, v132
    v_xor_b32 v133, s70, v133
    v_xor_b32 v134, s70, v134
    v_xor_b32 v135, s70, v135
    v_or3_b32 v4, v128, v129, v130
    v_or3_b32 v4, v4, v131, v132
    v_or3_b32 v4, v4, v133, v134
    v_or3_b32 v4, v4, v135, v135
    v_and_b32 v4, 0xff, v4
    v_cmp_ne_u32 vcc, 0, v4
    s_cbranch_scc0 L_q_ok
    s_cbranch_vccnz L_q_retry
L_q_ok:
    v_add_f32 v128, v128, v132
    v_add_f32 v129, v129, v133
    v_add_f32 v130, v130, v134
    v_add_f32 v131, v131, v135
    v_cvt_pk_bf16_f32 v4, v128, v129
    v_cvt_pk_bf16_f32 v5, v130, v131
    ds_write_b64 v14, v[4:5]
    ds_read_b128 v[32:35], v27 offset:0
    ds_read_b128 v[36:39], v27 offset:64
    ds_read_b128 v[40:43], v27 offset:128
    ds_read_b128 v[44:47], v27 offset:192
    s_waitcnt lgkmcnt(3)
    v_mfma_f32_16x16x32_bf16 v[112:115], v[48:51], v[32:35], 0
    v_mfma_f32_16x16x32_bf16 v[116:119], v[64:67], v[32:35], 0
    v_mfma_f32_16x16x32_bf16 v[120:123], v[80:83], v[32:35], 0
    v_mfma_f32_16x16x32_bf16 v[124:127], v[96:99], v[32:35], 0
    s_waitcnt lgkmcnt(2)
    v_mfma_f32_16x16x32_bf16 v[112:115], v[52:55], v[36:39], v[112:115]
    v_mfma_f32_16x16x32_bf16 v[116:119], v[68:71], v[36:39], v[116:119]
    v_mfma_f32_16x16x32_bf16 v[120:123], v[84:87], v[36:39], v[120:123]
    v_mfma_f32_16x16x32_bf16 v[124:127], v[100:103], v[36:39], v[124:127]
    s_waitcnt lgkmcnt(1)
    v_mfma_f32_16x16x32_bf16 v[112:115], v[56:59], v[40:43], v[112:115]
    v_mfma_f32_16x16x32_bf16 v[116:119], v[72:75], v[40:43], v[116:119]
    v_mfma_f32_16x16x32_bf16 v[120:123], v[88:91], v[40:43], v[120:123]
    v_mfma_f32_16x16x32_bf16 v[124:127], v[104:107], v[40:43], v[124:127]
    s_waitcnt lgkmcnt(0)
    v_mfma_f32_16x16x32_bf16 v[112:115], v[60:63], v[44:47], v[112:115]
    v_mfma_f32_16x16x32_bf16 v[116:119], v[76:79], v[44:47], v[116:119]
    v_mfma_f32_16x16x32_bf16 v[120:123], v[92:95], v[44:47], v[120:123]
    v_mfma_f32_16x16x32_bf16 v[124:127], v[108:111], v[44:47], v[124:127]
    s_mov_b32 s4, 0x3fb8aa3b
    s_mov_b32 s5, 0
    s_nop 2
    v_mov_b32 v6, 0x3db504f3
    v_mov_b32 v7, 0x3db504f3
    v_cvt_pk_bf16_f32 v48, v112, v113
    v_cvt_pk_bf16_f32 v49, v114, v115
    v_cvt_pk_bf16_f32 v50, v116, v117
    v_cvt_pk_bf16_f32 v51, v118, v119
    v_cvt_pk_bf16_f32 v52, v120, v121
    v_cvt_pk_bf16_f32 v53, v122, v123
    v_cvt_pk_bf16_f32 v54, v124, v125
    v_cvt_pk_bf16_f32 v55, v126, v127
    v_lshlrev_b32 v112, 16, v48
    v_and_b32 v113, 0xffff0000, v48
    v_lshlrev_b32 v114, 16, v49
    v_and_b32 v115, 0xffff0000, v49
    v_lshlrev_b32 v116, 16, v50
    v_and_b32 v117, 0xffff0000, v50
    v_lshlrev_b32 v118, 16, v51
    v_and_b32 v119, 0xffff0000, v51
    v_lshlrev_b32 v120, 16, v52
    v_and_b32 v121, 0xffff0000, v52
    v_lshlrev_b32 v122, 16, v53
    v_and_b32 v123, 0xffff0000, v53
    v_lshlrev_b32 v124, 16, v54
    v_and_b32 v125, 0xffff0000, v54
    v_lshlrev_b32 v126, 16, v55
    v_and_b32 v127, 0xffff0000, v55
    v_pk_mul_f32 v[112:113], v[112:113], v[6:7]
    v_pk_mul_f32 v[114:115], v[114:115], v[6:7]
    v_pk_mul_f32 v[116:117], v[116:117], v[6:7]
    v_pk_mul_f32 v[118:119], v[118:119], v[6:7]
    v_pk_mul_f32 v[120:121], v[120:121], v[6:7]
    v_pk_mul_f32 v[122:123], v[122:123], v[6:7]
    v_pk_mul_f32 v[124:125], v[124:125], v[6:7]
    v_pk_mul_f32 v[126:127], v[126:127], v[6:7]
    v_cvt_pk_bf16_f32 v48, v112, v113
    v_cvt_pk_bf16_f32 v49, v114, v115
    v_cvt_pk_bf16_f32 v50, v116, v117
    v_cvt_pk_bf16_f32 v51, v118, v119
    v_cvt_pk_bf16_f32 v52, v120, v121
    v_cvt_pk_bf16_f32 v53, v122, v123
    v_cvt_pk_bf16_f32 v54, v124, v125
    v_cvt_pk_bf16_f32 v55, v126, v127
    v_lshlrev_b32 v112, 16, v48
    v_and_b32 v113, 0xffff0000, v48
    v_lshlrev_b32 v114, 16, v49
    v_and_b32 v115, 0xffff0000, v49
    v_lshlrev_b32 v116, 16, v50
    v_and_b32 v117, 0xffff0000, v50
    v_lshlrev_b32 v118, 16, v51
    v_and_b32 v119, 0xffff0000, v51
    v_lshlrev_b32 v120, 16, v52
    v_and_b32 v121, 0xffff0000, v52
    v_lshlrev_b32 v122, 16, v53
    v_and_b32 v123, 0xffff0000, v53
    v_lshlrev_b32 v124, 16, v54
    v_and_b32 v125, 0xffff0000, v54
    v_lshlrev_b32 v126, 16, v55
    v_and_b32 v127, 0xffff0000, v55
    v_max3_f32 v4, v112, v113, v114
    v_max3_f32 v4, v4, v115, v116
    v_max3_f32 v4, v4, v117, v118
    v_max3_f32 v4, v4, v119, v120
    v_max3_f32 v4, v4, v121, v122
    v_max3_f32 v4, v4, v123, v124
    v_max3_f32 v4, v4, v125, v126
    v_max3_f32 v4, v4, v127, v127
    v_mov_b32 v5, v4
    s_nop 1
    v_permlane32_swap_b32 v4, v5
    v_max_f32 v4, v4, v5
    v_mov_b32 v5, v4
    s_nop 1
    v_permlane16_swap_b32 v4, v5
    v_max_f32 v4, v4, v5
    v_min_u32 v4, -2, v4
    s_mov_b64 exec, 3
    ds_write_b32 v13, v4
    s_mov_b64 exec, -1
L_mx_retry:
    ds_read_b128 v[40:43], v12
    s_waitcnt lgkmcnt(0)
    v_max3_u32 v6, v40, v41, v42
    v_max3_u32 v6, v6, v43, v43
    v_cmp_eq_u32 vcc, -1, v6
    s_cbranch_vccz L_mx_ok
    s_add_u32 s5, s5, 1
    s_cmp_lt_u32 s5, 300000
    s_cbranch_scc1 L_mx_retry
L_mx_ok:
    v_max3_f32 v4, v40, v41, v42
    v_max_f32 v44, v4, v43
    v_mul_f32 v5, s4, v44
    v_fma_f32 v112, v112, s4, -v5
    v_fma_f32 v113, v113, s4, -v5
    v_fma_f32 v114, v114, s4, -v5
    v_fma_f32 v115, v115, s4, -v5
    v_fma_f32 v116, v116, s4, -v5
    v_fma_f32 v117, v117, s4, -v5
    v_fma_f32 v118, v118, s4, -v5
    v_fma_f32 v119, v119, s4, -v5
    v_fma_f32 v120, v120, s4, -v5
    v_fma_f32 v121, v121, s4, -v5
    v_fma_f32 v122, v122, s4, -v5
    v_fma_f32 v123, v123, s4, -v5
    v_fma_f32 v124, v124, s4, -v5
    v_fma_f32 v125, v125, s4, -v5
    v_fma_f32 v126, v126, s4, -v5
    v_fma_f32 v127, v127, s4, -v5
    v_exp_f32 v112, v112
    v_exp_f32 v113, v113
    v_exp_f32 v114, v114
    v_exp_f32 v115, v115
    v_exp_f32 v116, v116
    v_exp_f32 v117, v117
    v_exp_f32 v118, v118
    v_exp_f32 v119, v119
    v_exp_f32 v120, v120
    v_exp_f32 v121, v121
    v_exp_f32 v122, v122
    v_exp_f32 v123, v123
    v_exp_f32 v124, v124
    v_exp_f32 v125, v125
    v_exp_f32 v126, v126
    v_exp_f32 v127, v127
    v_add_f32 v4, v112, v113
    v_add_f32 v5, v114, v115
    v_add_f32 v4, v4, v116
    v_add_f32 v5, v5, v117
    v_add_f32 v4, v4, v118
    v_add_f32 v5, v5, v119
    v_add_f32 v4, v4, v120
    v_add_f32 v5, v5, v121
    v_add_f32 v4, v4, v122
    v_add_f32 v5, v5, v123
    v_add_f32 v4, v4, v124
    v_add_f32 v5, v5, v125
    v_add_f32 v4, v4, v126
    v_add_f32 v5, v5, v127
    v_add_f32 v4, v4, v5
    v_cvt_pk_bf16_f32 v48, v112, v113
    v_cvt_pk_bf16_f32 v49, v114, v115
    v_cvt_pk_bf16_f32 v50, v116, v117
    v_cvt_pk_bf16_f32 v51, v118, v119
    v_cvt_pk_bf16_f32 v52, v120, v121
    v_cvt_pk_bf16_f32 v53, v122, v123
    v_cvt_pk_bf16_f32 v54, v124, v125
    v_cvt_pk_bf16_f32 v55, v126, v127
    v_mov_b32 v5, v4
    s_mov_b64 exec, s[52:53]
    ds_write_b64 v21, v[48:49]
    ds_write_b64 v21, v[50:51] offset:32
    ds_write_b64 v21, v[52:53] offset:64
    ds_write_b64 v21, v[54:55] offset:96
    s_mov_b64 exec, -1
    v_permlane32_swap_b32 v4, v5
    v_add_f32 v4, v4, v5
    v_mov_b32 v5, v4
    s_nop 1
    v_permlane16_swap_b32 v4, v5
    v_add_f32 v4, v4, v5
    v_min_u32 v4, -2, v4
    s_mov_b64 exec, 3
    ds_write_b32 v13, v4 offset:32
    s_mov_b64 exec, -1
    s_waitcnt lgkmcnt(0)
    s_sub_u32 s4, s7, 3
    s_cmp_ge_u32 s4, 3
    s_cbranch_scc1 L_rp_done
    s_cmp_ge_u32 s8, 12
    s_cbranch_scc1 L_rp_done
    s_mul_i32 s5, s8, 3
    s_add_u32 s4, s4, s5
    s_mul_i32 s4, s4, 10240
    s_mul_i32 s5, s43, 2560
    s_add_u32 s4, s4, s5
    s_add_u32 s4, s4, 698624
    buffer_load_dwordx4 v[192:195], v31, s[60:63], s4 offen sc1
    buffer_load_dwordx4 v[192:195], v31, s[60:63], s4 offen offset:1024 sc1
    s_mov_b32 exec_hi, 0
    buffer_load_dwordx4 v[192:195], v31, s[60:63], s4 offen offset:2048 sc1
    s_mov_b32 exec_hi, -1
L_rp_done:
    s_cmp_lg_u32 s43, 0
    s_cbranch_scc1 L_st_done
    s_mov_b32 s5, 0
L_ls_retry:
    ds_read_b128 v[40:43], v12 offset:32
    s_waitcnt lgkmcnt(0)
    v_max3_u32 v6, v40, v41, v42
    v_max3_u32 v6, v6, v43, v43
    v_cmp_eq_u32 vcc, -1, v6
    s_cbranch_vccz L_ls_ok
    s_add_u32 s5, s5, 1
    s_cmp_lt_u32 s5, 300000
    s_cbranch_scc1 L_ls_retry
L_ls_ok:
    v_add_f32 v45, v40, v41
    v_add_f32 v4, v42, v43
    v_add_f32 v45, v45, v4
    v_and_b32 v4, 0xffff0000, v44
    v_and_b32 v6, 0xffff0000, v45
    v_lshl_or_b32 v5, v44, 16, s68
    v_lshl_or_b32 v7, v45, 16, s68
    v_or_b32 v4, s68, v4
    v_or_b32 v6, s68, v6
    s_mov_b64 exec, 3
    s_cmp_lg_u32 s71, 0
    s_cbranch_scc0 L_st_far
    buffer_store_dwordx4 v[4:7], v31, s[60:63], s75 offen
L_st_pub:
    s_mov_b64 exec, -1
L_st_done:
    s_barrier
    ds_read_b128 v[48:51], v22 offset:0
    ds_read_b128 v[52:55], v22 offset:64
    ds_read_b128 v[56:59], v22 offset:128
    ds_read_b128 v[60:63], v22 offset:192
    ds_read_b128 v[64:67], v22 offset:256
    ds_read_b128 v[68:71], v22 offset:320
    ds_read_b128 v[72:75], v22 offset:384
    ds_read_b128 v[76:79], v22 offset:448
    s_waitcnt lgkmcnt(0)
    ds_read_b64_tr_b16 v[80:81], v10 offset:0
    ds_read_b64_tr_b16 v[82:83], v10 offset:1024
    ds_read_b64_tr_b16 v[84:85], v11 offset:0
    ds_read_b64_tr_b16 v[86:87], v11 offset:1024
    ds_read_b64_tr_b16 v[88:89], v10 offset:8192
    ds_read_b64_tr_b16 v[90:91], v10 offset:9216
    ds_read_b64_tr_b16 v[92:93], v11 offset:8192
    ds_read_b64_tr_b16 v[94:95], v11 offset:9216
    ds_read_b64_tr_b16 v[96:97], v10 offset:16384
    ds_read_b64_tr_b16 v[98:99], v10 offset:17408
    ds_read_b64_tr_b16 v[100:101], v11 offset:16384
    ds_read_b64_tr_b16 v[102:103], v11 offset:17408
    s_waitcnt lgkmcnt(8)
    v_mfma_f32_16x16x32_bf16 v[32:35], v[80:83], v[48:51], 0
    ds_read_b64_tr_b16 v[104:105], v10 offset:24576
    ds_read_b64_tr_b16 v[106:107], v10 offset:25600
    ds_read_b64_tr_b16 v[108:109], v11 offset:24576
    ds_read_b64_tr_b16 v[110:111], v11 offset:25600
    v_mfma_f32_16x16x32_bf16 v[36:39], v[84:87], v[48:51], 0
    s_waitcnt lgkmcnt(8)
    v_mfma_f32_16x16x32_bf16 v[32:35], v[88:91], v[52:55], v[32:35]
    ds_read_b64_tr_b16 v[112:113], v10 offset:32768
    ds_read_b64_tr_b16 v[114:115], v10 offset:33792
    ds_read_b64_tr_b16 v[116:117], v11 offset:32768
    ds_read_b64_tr_b16 v[118:119], v11 offset:33792
    v_mfma_f32_16x16x32_bf16 v[36:39], v[92:95], v[52:55], v[36:39]
    s_waitcnt lgkmcnt(8)
    v_mfma_f32_16x16x32_bf16 v[32:35], v[96:99], v[56:59], v[32:35]
    ds_read_b64_tr_b16 v[120:121], v10 offset:40960
    ds_read_b64_tr_b16 v[122:123], v10 offset:41984
    ds_read_b64_tr_b16 v[124:125], v11 offset:40960
    ds_read_b64_tr_b16 v[126:127], v11 offset:41984
    v_mfma_f32_16x16x32_bf16 v[36:39], v[100:103], v[56:59], v[36:39]
    s_waitcnt lgkmcnt(8)
    v_mfma_f32_16x16x32_bf16 v[32:35], v[104:107], v[60:63], v[32:35]
    v_mfma_f32_16x16x32_bf16 v[36:39], v[108:111], v[60:63], v[36:39]
    s_waitcnt lgkmcnt(4)
    v_mfma_f32_16x16x32_bf16 v[32:35], v[112:115], v[64:67], v[32:35]
    v_mfma_f32_16x16x32_bf16 v[36:39], v[116:119], v[64:67], v[36:39]
    s_waitcnt lgkmcnt(0)
    v_mfma_f32_16x16x32_bf16 v[32:35], v[120:123], v[68:71], v[32:35]
    v_mfma_f32_16x16x32_bf16 v[36:39], v[124:127], v[68:71], v[36:39]
    s_cmp_lt_u32 s7, 3
    s_cbranch_scc0 L_m_done
    buffer_load_dwordx4 v[152:155], v23, s[60:63], s72 offen sc1
    ds_read_b64_tr_b16 v[184:185], v9 offset:0
    ds_read_b64_tr_b16 v[186:187], v9 offset:512
    ds_read_b64_tr_b16 v[188:189], v9 offset:4096
    ds_read_b64_tr_b16 v[190:191], v9 offset:4608
    ds_read_b64_tr_b16 v[216:217], v9 offset:8192
    ds_read_b64_tr_b16 v[218:219], v9 offset:8704
    ds_read_b64_tr_b16 v[220:221], v9 offset:12288
    ds_read_b64_tr_b16 v[222:223], v9 offset:12800
    ds_read_b64_tr_b16 v[248:249], v9 offset:16384
    ds_read_b64_tr_b16 v[250:251], v9 offset:16896
    ds_read_b64_tr_b16 v[252:253], v9 offset:20480
    ds_read_b64_tr_b16 v[254:255], v9 offset:20992
    s_waitcnt lgkmcnt(0)
L_m_done:
    s_barrier
    ds_read_b64_tr_b16 v[128:129], v10 offset:49152
    ds_read_b64_tr_b16 v[130:131], v10 offset:50176
    ds_read_b64_tr_b16 v[132:133], v11 offset:49152
    ds_read_b64_tr_b16 v[134:135], v11 offset:50176
    ds_read_b64_tr_b16 v[136:137], v10 offset:57344
    ds_read_b64_tr_b16 v[138:139], v10 offset:58368
    ds_read_b64_tr_b16 v[140:141], v11 offset:57344
    ds_read_b64_tr_b16 v[142:143], v11 offset:58368
    s_waitcnt lgkmcnt(4)
    v_mfma_f32_16x16x32_bf16 v[32:35], v[128:131], v[72:75], v[32:35]
    v_mfma_f32_16x16x32_bf16 v[36:39], v[132:135], v[72:75], v[36:39]
    s_waitcnt lgkmcnt(0)
    v_mfma_f32_16x16x32_bf16 v[32:35], v[136:139], v[76:79], v[32:35]
    v_mfma_f32_16x16x32_bf16 v[36:39], v[140:143], v[76:79], v[36:39]
    s_mov_b64 exec, s[52:53]
    s_nop 5
    v_bfi_b32 v40, v144, v32, s70
    v_bfi_b32 v41, v144, v33, s70
    v_bfi_b32 v42, v144, v34, s70
    v_bfi_b32 v43, v144, v35, s70
    v_bfi_b32 v44, v144, v36, s70
    v_bfi_b32 v45, v144, v37, s70
    v_bfi_b32 v46, v144, v38, s70
    v_bfi_b32 v47, v144, v39, s70
    s_cmp_lg_u32 s71, 0
    s_cbranch_scc0 L_o_far
    buffer_store_dwordx4 v[40:43], v15, s[60:63], s74 offen
    buffer_store_dwordx4 v[44:47], v15, s[60:63], s74 offen offset:128
L_o_pub:
    s_mov_b64 exec, -1
    s_cmp_lt_u32 s7, 3
    s_cbranch_scc1 L_t_wo
    s_cmp_lg_u32 s54, 0
    s_cbranch_scc1 L_t_big
    s_mov_b32 exec_lo, 0xffffffff
    s_mov_b32 exec_hi, 0xffff
    buffer_load_dwordx4 v[160:163], v23, s[60:63], s72 offen sc1
    buffer_load_dwordx4 v[164:167], v23, s[60:63], s73 offen sc1
    buffer_load_dwordx4 v[168:171], v23, s[60:63], s48 offen sc1
    buffer_load_dwordx4 v[172:175], v23, s[60:63], s49 offen sc1
    s_mov_b64 exec, -1
    s_barrier
    s_mov_b32 s5, 0
    s_cmp_eq_u32 s5, 0
    s_branch L_hsmall_check
L_hsmall_retry:
    s_mov_b32 exec_lo, 0xffffffff
    s_mov_b32 exec_hi, 0xffff
    buffer_load_dwordx4 v[160:163], v23, s[60:63], s72 offen sc1
    buffer_load_dwordx4 v[164:167], v23, s[60:63], s73 offen sc1
    buffer_load_dwordx4 v[168:171], v23, s[60:63], s48 offen sc1
    buffer_load_dwordx4 v[172:175], v23, s[60:63], s49 offen sc1
    s_mov_b64 exec, -1
    s_add_u32 s5, s5, 1
    s_cmp_lt_u32 s5, 300000
L_hsmall_check:
    s_waitcnt vmcnt(0)
    v_bitop3_b32 v192, v160, v161, s70 bitop3:0x7e
    v_bitop3_b32 v193, v162, v163, s70 bitop3:0x7e
    v_bitop3_b32 v194, v164, v165, s70 bitop3:0x7e
    v_bitop3_b32 v195, v166, v167, s70 bitop3:0x7e
    v_bitop3_b32 v196, v168, v169, s70 bitop3:0x7e
    v_bitop3_b32 v197, v170, v171, s70 bitop3:0x7e
    v_bitop3_b32 v198, v172, v173, s70 bitop3:0x7e
    v_bitop3_b32 v199, v174, v175, s70 bitop3:0x7e
    v_or3_b32 v4, v192, v193, v194
    v_or3_b32 v4, v4, v195, v196
    v_or3_b32 v4, v4, v197, v198
    v_or3_b32 v4, v4, v199, v199
    v_and_b32 v4, 0xff, v4
    v_cmp_ne_u32 vcc, 0, v4
    s_cbranch_scc0 L_hsmall_ok
    s_cbranch_vccnz L_hsmall_retry
L_hsmall_ok:
    v_xor_b32 v160, s70, v160
    v_xor_b32 v161, s70, v161
    v_xor_b32 v162, s70, v162
    v_xor_b32 v163, s70, v163
    v_xor_b32 v164, s70, v164
    v_xor_b32 v165, s70, v165
    v_xor_b32 v166, s70, v166
    v_xor_b32 v167, s70, v167
    v_xor_b32 v168, s70, v168
    v_xor_b32 v169, s70, v169
    v_xor_b32 v170, s70, v170
    v_xor_b32 v171, s70, v171
    v_xor_b32 v172, s70, v172
    v_xor_b32 v173, s70, v173
    v_xor_b32 v174, s70, v174
    v_xor_b32 v175, s70, v175
    v_add_f32 v160, v160, v164
    v_add_f32 v161, v161, v165
    v_add_f32 v162, v162, v166
    v_add_f32 v163, v163, v167
    v_add_f32 v168, v168, v172
    v_add_f32 v169, v169, v173
    v_add_f32 v170, v170, v174
    v_add_f32 v171, v171, v175
    v_cvt_pk_bf16_f32 v164, v160, v161
    v_cvt_pk_bf16_f32 v165, v162, v163
    v_cvt_pk_bf16_f32 v166, v168, v169
    v_cvt_pk_bf16_f32 v167, v170, v171
    v_lshlrev_b32 v160, 16, v164
    v_and_b32 v161, 0xffff0000, v164
    v_lshlrev_b32 v162, 16, v165
    v_and_b32 v163, 0xffff0000, v165
    v_lshlrev_b32 v168, 16, v166
    v_and_b32 v169, 0xffff0000, v166
    v_lshlrev_b32 v170, 16, v167
    v_and_b32 v171, 0xffff0000, v167
    v_max_f32 v160, 0, v160
    v_max_f32 v161, 0, v161
    v_max_f32 v162, 0, v162
    v_max_f32 v163, 0, v163
    v_mul_f32 v160, v160, v168
    v_mul_f32 v161, v161, v169
    v_mul_f32 v162, v162, v170
    v_mul_f32 v163, v163, v171
    v_cvt_pk_bf16_f32 v4, v160, v161
    v_cvt_pk_bf16_f32 v5, v162, v163
    s_mov_b32 exec_lo, 0xffffffff
    s_mov_b32 exec_hi, 0xffff
    ds_write_b64 v24, v[4:5] offset:0
    s_mov_b64 exec, -1
    s_waitcnt lgkmcnt(0)
    s_barrier
    ds_read_b64_tr_b16 v[40:41], v9 offset:0
    ds_read_b64_tr_b16 v[42:43], v9 offset:512
    ds_read_b128 v[44:47], v25 offset:0
    ds_read_b64_tr_b16 v[48:49], v9 offset:4096
    ds_read_b64_tr_b16 v[50:51], v9 offset:4608
    ds_read_b128 v[52:55], v25 offset:256
    ds_read_b64_tr_b16 v[56:57], v9 offset:8192
    ds_read_b64_tr_b16 v[58:59], v9 offset:8704
    ds_read_b128 v[60:63], v25 offset:512
    ds_read_b64_tr_b16 v[64:65], v9 offset:12288
    ds_read_b64_tr_b16 v[66:67], v9 offset:12800
    ds_read_b128 v[68:71], v25 offset:768
    ds_read_b64_tr_b16 v[72:73], v9 offset:16384
    ds_read_b64_tr_b16 v[74:75], v9 offset:16896
    ds_read_b128 v[76:79], v25 offset:1024
    s_waitcnt lgkmcnt(12)
    v_mfma_f32_16x16x32_bf16 v[32:35], v[40:43], v[44:47], 0
    ds_read_b64_tr_b16 v[40:41], v9 offset:20480
    ds_read_b64_tr_b16 v[42:43], v9 offset:20992
    ds_read_b128 v[44:47], v25 offset:1280
    s_waitcnt lgkmcnt(12)
    v_mfma_f32_16x16x32_bf16 v[32:35], v[48:51], v[52:55], v[32:35]
    s_waitcnt lgkmcnt(9)
    v_mfma_f32_16x16x32_bf16 v[32:35], v[56:59], v[60:63], v[32:35]
    s_waitcnt lgkmcnt(6)
    v_mfma_f32_16x16x32_bf16 v[32:35], v[64:67], v[68:71], v[32:35]
    s_waitcnt lgkmcnt(3)
    v_mfma_f32_16x16x32_bf16 v[32:35], v[72:75], v[76:79], v[32:35]
    s_waitcnt lgkmcnt(0)
    v_mfma_f32_16x16x32_bf16 v[32:35], v[40:43], v[44:47], v[32:35]
    s_mov_b64 exec, s[56:57]
    s_nop 6
    v_bfi_b32 v32, v144, v32, s70
    v_bfi_b32 v33, v144, v33, s70
    v_bfi_b32 v34, v144, v34, s70
    v_bfi_b32 v35, v144, v35, s70
    buffer_store_dwordx4 v[32:35], v15, s[60:63], s65 offen sc1
    s_endpgm
L_t_big:
    s_mul_i32 s4, s43, 5
    s_add_u32 s4, s4, 4
    s_min_u32 s4, s4, 17
    s_lshr_b32 s5, s12, 1
    s_add_u32 s4, s4, s5
    s_lshl_b32 s4, s4, 8
    v_lshl_add_u32 v145, v3, 4, s4
    buffer_load_dwordx4 v[160:163], v23, s[60:63], s72 offen sc1
    buffer_load_dwordx4 v[164:167], v23, s[60:63], s73 offen sc1
    buffer_load_dwordx4 v[168:171], v23, s[60:63], s48 offen sc1
    buffer_load_dwordx4 v[172:175], v23, s[60:63], s49 offen sc1
    s_mov_b32 exec_lo, 0xffff
    s_mov_b32 exec_hi, 0x0
    buffer_load_dwordx4 v[176:179], v145, s[60:63], s72 offen sc1
    buffer_load_dwordx4 v[180:183], v145, s[60:63], s73 offen sc1
    buffer_load_dwordx4 v[184:187], v145, s[60:63], s48 offen sc1
    buffer_load_dwordx4 v[188:191], v145, s[60:63], s49 offen sc1
    s_mov_b64 exec, -1
    s_barrier
    s_mov_b32 s5, 0
    s_cmp_eq_u32 s5, 0
    s_branch L_hbig_check
L_hbig_retry:
    buffer_load_dwordx4 v[160:163], v23, s[60:63], s72 offen sc1
    buffer_load_dwordx4 v[164:167], v23, s[60:63], s73 offen sc1
    buffer_load_dwordx4 v[168:171], v23, s[60:63], s48 offen sc1
    buffer_load_dwordx4 v[172:175], v23, s[60:63], s49 offen sc1
    s_mov_b32 exec_lo, 0xffff
    s_mov_b32 exec_hi, 0x0
    buffer_load_dwordx4 v[176:179], v145, s[60:63], s72 offen sc1
    buffer_load_dwordx4 v[180:183], v145, s[60:63], s73 offen sc1
    buffer_load_dwordx4 v[184:187], v145, s[60:63], s48 offen sc1
    buffer_load_dwordx4 v[188:191], v145, s[60:63], s49 offen sc1
    s_mov_b64 exec, -1
    s_add_u32 s5, s5, 1
    s_cmp_lt_u32 s5, 300000
L_hbig_check:
    s_waitcnt vmcnt(0)
    v_bitop3_b32 v192, v160, v161, s70 bitop3:0x7e
    v_bitop3_b32 v193, v162, v163, s70 bitop3:0x7e
    v_bitop3_b32 v194, v164, v165, s70 bitop3:0x7e
    v_bitop3_b32 v195, v166, v167, s70 bitop3:0x7e
    v_bitop3_b32 v196, v168, v169, s70 bitop3:0x7e
    v_bitop3_b32 v197, v170, v171, s70 bitop3:0x7e
    v_bitop3_b32 v198, v172, v173, s70 bitop3:0x7e
    v_bitop3_b32 v199, v174, v175, s70 bitop3:0x7e
    v_bitop3_b32 v200, v176, v177, s70 bitop3:0x7e
    v_bitop3_b32 v201, v178, v179, s70 bitop3:0x7e
    v_bitop3_b32 v202, v180, v181, s70 bitop3:0x7e
    v_bitop3_b32 v203, v182, v183, s70 bitop3:0x7e
    v_bitop3_b32 v204, v184, v185, s70 bitop3:0x7e
    v_bitop3_b32 v205, v186, v187, s70 bitop3:0x7e
    v_bitop3_b32 v206, v188, v189, s70 bitop3:0x7e
    v_bitop3_b32 v207, v190, v191, s70 bitop3:0x7e
    v_or3_b32 v4, v192, v193, v194
    v_or3_b32 v4, v4, v195, v196
    v_or3_b32 v4, v4, v197, v198
    v_or3_b32 v4, v4, v199, v200
    v_or3_b32 v4, v4, v201, v202
    v_or3_b32 v4, v4, v203, v204
    v_or3_b32 v4, v4, v205, v206
    v_or3_b32 v4, v4, v207, v207
    v_and_b32 v4, 0xff, v4
    v_cmp_ne_u32 vcc, 0, v4
    s_cbranch_scc0 L_hbig_ok
    s_cbranch_vccnz L_hbig_retry
L_hbig_ok:
    v_xor_b32 v160, s70, v160
    v_xor_b32 v161, s70, v161
    v_xor_b32 v162, s70, v162
    v_xor_b32 v163, s70, v163
    v_xor_b32 v164, s70, v164
    v_xor_b32 v165, s70, v165
    v_xor_b32 v166, s70, v166
    v_xor_b32 v167, s70, v167
    v_xor_b32 v168, s70, v168
    v_xor_b32 v169, s70, v169
    v_xor_b32 v170, s70, v170
    v_xor_b32 v171, s70, v171
    v_xor_b32 v172, s70, v172
    v_xor_b32 v173, s70, v173
    v_xor_b32 v174, s70, v174
    v_xor_b32 v175, s70, v175
    v_add_f32 v160, v160, v164
    v_add_f32 v161, v161, v165
    v_add_f32 v162, v162, v166
    v_add_f32 v163, v163, v167
    v_add_f32 v168, v168, v172
    v_add_f32 v169, v169, v173
    v_add_f32 v170, v170, v174
    v_add_f32 v171, v171, v175
    v_cvt_pk_bf16_f32 v164, v160, v161
    v_cvt_pk_bf16_f32 v165, v162, v163
    v_cvt_pk_bf16_f32 v166, v168, v169
    v_cvt_pk_bf16_f32 v167, v170, v171
    v_lshlrev_b32 v160, 16, v164
    v_and_b32 v161, 0xffff0000, v164
    v_lshlrev_b32 v162, 16, v165
    v_and_b32 v163, 0xffff0000, v165
    v_lshlrev_b32 v168, 16, v166
    v_and_b32 v169, 0xffff0000, v166
    v_lshlrev_b32 v170, 16, v167
    v_and_b32 v171, 0xffff0000, v167
    v_max_f32 v160, 0, v160
    v_max_f32 v161, 0, v161
    v_max_f32 v162, 0, v162
    v_max_f32 v163, 0, v163
    v_mul_f32 v160, v160, v168
    v_mul_f32 v161, v161, v169
    v_mul_f32 v162, v162, v170
    v_mul_f32 v163, v163, v171
    v_cvt_pk_bf16_f32 v4, v160, v161
    v_cvt_pk_bf16_f32 v5, v162, v163
    ds_write_b64 v24, v[4:5] offset:0
    v_xor_b32 v176, s70, v176
    v_xor_b32 v177, s70, v177
    v_xor_b32 v178, s70, v178
    v_xor_b32 v179, s70, v179
    v_xor_b32 v180, s70, v180
    v_xor_b32 v181, s70, v181
    v_xor_b32 v182, s70, v182
    v_xor_b32 v183, s70, v183
    v_xor_b32 v184, s70, v184
    v_xor_b32 v185, s70, v185
    v_xor_b32 v186, s70, v186
    v_xor_b32 v187, s70, v187
    v_xor_b32 v188, s70, v188
    v_xor_b32 v189, s70, v189
    v_xor_b32 v190, s70, v190
    v_xor_b32 v191, s70, v191
    v_add_f32 v176, v176, v180
    v_add_f32 v177, v177, v181
    v_add_f32 v178, v178, v182
    v_add_f32 v179, v179, v183
    v_add_f32 v184, v184, v188
    v_add_f32 v185, v185, v189
    v_add_f32 v186, v186, v190
    v_add_f32 v187, v187, v191
    v_cvt_pk_bf16_f32 v180, v176, v177
    v_cvt_pk_bf16_f32 v181, v178, v179
    v_cvt_pk_bf16_f32 v182, v184, v185
    v_cvt_pk_bf16_f32 v183, v186, v187
    v_lshlrev_b32 v176, 16, v180
    v_and_b32 v177, 0xffff0000, v180
    v_lshlrev_b32 v178, 16, v181
    v_and_b32 v179, 0xffff0000, v181
    v_lshlrev_b32 v184, 16, v182
    v_and_b32 v185, 0xffff0000, v182
    v_lshlrev_b32 v186, 16, v183
    v_and_b32 v187, 0xffff0000, v183
    v_max_f32 v176, 0, v176
    v_max_f32 v177, 0, v177
    v_max_f32 v178, 0, v178
    v_max_f32 v179, 0, v179
    v_mul_f32 v176, v176, v184
    v_mul_f32 v177, v177, v185
    v_mul_f32 v178, v178, v186
    v_mul_f32 v179, v179, v187
    v_cvt_pk_bf16_f32 v4, v176, v177
    v_cvt_pk_bf16_f32 v5, v178, v179
    s_mov_b32 exec_lo, 0xffff
    s_mov_b32 exec_hi, 0x0
    ds_write_b64 v24, v[4:5] offset:512
    s_mov_b64 exec, -1
    s_waitcnt lgkmcnt(0)
    s_barrier
    ds_read_b64_tr_b16 v[40:41], v9 offset:0
    ds_read_b64_tr_b16 v[42:43], v9 offset:512
    ds_read_b128 v[44:47], v25 offset:0
    ds_read_b64_tr_b16 v[48:49], v9 offset:4096
    ds_read_b64_tr_b16 v[50:51], v9 offset:4608
    ds_read_b128 v[52:55], v25 offset:256
    ds_read_b64_tr_b16 v[56:57], v9 offset:8192
    ds_read_b64_tr_b16 v[58:59], v9 offset:8704
    ds_read_b128 v[60:63], v25 offset:512
    ds_read_b64_tr_b16 v[64:65], v9 offset:12288
    ds_read_b64_tr_b16 v[66:67], v9 offset:12800
    ds_read_b128 v[68:71], v25 offset:768
    ds_read_b64_tr_b16 v[72:73], v9 offset:16384
    ds_read_b64_tr_b16 v[74:75], v9 offset:16896
    ds_read_b128 v[76:79], v25 offset:1024
    s_waitcnt lgkmcnt(12)
    v_mfma_f32_16x16x32_bf16 v[32:35], v[40:43], v[44:47], 0
    ds_read_b64_tr_b16 v[40:41], v9 offset:20480
    ds_read_b64_tr_b16 v[42:43], v9 offset:20992
    ds_read_b128 v[44:47], v25 offset:1280
    s_waitcnt lgkmcnt(12)
    v_mfma_f32_16x16x32_bf16 v[32:35], v[48:51], v[52:55], v[32:35]
    ds_read_b64_tr_b16 v[48:49], v9 offset:24576
    ds_read_b64_tr_b16 v[50:51], v9 offset:25088
    ds_read_b128 v[52:55], v25 offset:1536
    s_waitcnt lgkmcnt(12)
    v_mfma_f32_16x16x32_bf16 v[32:35], v[56:59], v[60:63], v[32:35]
    ds_read_b64_tr_b16 v[56:57], v8 offset:0
    ds_read_b64_tr_b16 v[58:59], v8 offset:512
    ds_read_b128 v[60:63], v25 offset:1792
    s_waitcnt lgkmcnt(12)
    v_mfma_f32_16x16x32_bf16 v[32:35], v[64:67], v[68:71], v[32:35]
    ds_read_b64_tr_b16 v[64:65], v8 offset:4096
    ds_read_b64_tr_b16 v[66:67], v8 offset:4608
    ds_read_b128 v[68:71], v25 offset:2048
    s_waitcnt lgkmcnt(12)
    v_mfma_f32_16x16x32_bf16 v[32:35], v[72:75], v[76:79], v[32:35]
    s_waitcnt lgkmcnt(9)
    v_mfma_f32_16x16x32_bf16 v[32:35], v[40:43], v[44:47], v[32:35]
    s_waitcnt lgkmcnt(6)
    v_mfma_f32_16x16x32_bf16 v[32:35], v[48:51], v[52:55], v[32:35]
    s_waitcnt lgkmcnt(3)
    v_mfma_f32_16x16x32_bf16 v[32:35], v[56:59], v[60:63], v[32:35]
    s_waitcnt lgkmcnt(0)
    v_mfma_f32_16x16x32_bf16 v[32:35], v[64:67], v[68:71], v[32:35]
    s_mov_b64 exec, s[56:57]
    s_nop 6
    v_bfi_b32 v32, v144, v32, s70
    v_bfi_b32 v33, v144, v33, s70
    v_bfi_b32 v34, v144, v34, s70
    v_bfi_b32 v35, v144, v35, s70
    buffer_store_dwordx4 v[32:35], v15, s[60:63], s65 offen sc1
    s_endpgm
L_t_wo:
    buffer_load_dwordx4 v[112:115], v31, s[60:63], s73 offen offset:0 sc1
    buffer_load_dwordx4 v[116:119], v31, s[60:63], s73 offen offset:1024 sc1
    buffer_load_dwordx4 v[120:123], v31, s[60:63], s73 offen offset:2048 sc1
    buffer_load_dwordx4 v[124:127], v31, s[60:63], s73 offen offset:3072 sc1
    s_waitcnt vmcnt(6)
    s_mov_b32 s5, 0
    s_cmp_eq_u32 s5, 0
    s_branch L_st_check
L_st_retry:
    buffer_load_dwordx4 v[152:155], v23, s[60:63], s72 offen sc1
    s_waitcnt vmcnt(0)
    s_add_u32 s5, s5, 1
    s_cmp_lt_u32 s5, 300000
L_st_check:
    v_bitop3_b32 v4, v152, v153, s68 bitop3:0x7e
    v_bitop3_b32 v5, v154, v155, s68 bitop3:0x7e
    v_or_b32 v4, v4, v5
    v_cmp_ne_u16 vcc, 0, v4
    s_cbranch_scc0 L_st_ok
    s_cbranch_vccnz L_st_retry
L_st_ok:
    v_perm_b32 v52, v152, v153, s55
    v_perm_b32 v53, v154, v155, s55
    s_mov_b32 s4, 0x3fb8aa3b
    v_max_f32_dpp v5, v52, v52 quad_perm:[1,0,3,2] row_mask:0xf bank_mask:0xf
    s_nop 1
    v_max_f32_dpp v5, v5, v5 quad_perm:[2,3,0,1] row_mask:0xf bank_mask:0xf
    v_sub_f32 v5, v52, v5
    v_mul_f32 v5, s4, v5
    v_exp_f32 v5, v5
    s_nop 0
    v_mul_f32 v7, v5, v53
    s_nop 1
    v_add_f32_dpp v7, v7, v7 quad_perm:[1,0,3,2] row_mask:0xf bank_mask:0xf
    s_nop 1
    v_add_f32_dpp v7, v7, v7 quad_perm:[2,3,0,1] row_mask:0xf bank_mask:0xf
    v_rcp_f32 v7, v7
    s_nop 0
    v_mul_f32 v5, v5, v7
    s_mov_b32 s5, 0
    s_nop 0
    v_mov_b32_dpp v148, v5 quad_perm:[0,0,0,0] row_mask:0xf bank_mask:0xf
    v_mov_b32_dpp v149, v5 quad_perm:[1,1,1,1] row_mask:0xf bank_mask:0xf
    v_mov_b32_dpp v150, v5 quad_perm:[2,2,2,2] row_mask:0xf bank_mask:0xf
    v_mov_b32_dpp v151, v5 quad_perm:[3,3,3,3] row_mask:0xf bank_mask:0xf
    s_mov_b32 s5, 0
    s_cmp_eq_u32 s5, 0
    s_branch L_o_check
L_o_retry:
    buffer_load_dwordx4 v[112:115], v31, s[60:63], s73 offen offset:0 sc1
    buffer_load_dwordx4 v[116:119], v31, s[60:63], s73 offen offset:1024 sc1
    buffer_load_dwordx4 v[120:123], v31, s[60:63], s73 offen offset:2048 sc1
    buffer_load_dwordx4 v[124:127], v31, s[60:63], s73 offen offset:3072 sc1
    s_add_u32 s5, s5, 1
    s_cmp_lt_u32 s5, 300000
L_o_check:
    s_waitcnt vmcnt(0)
    v_xor_b32 v112, s70, v112
    v_xor_b32 v113, s70, v113
    v_xor_b32 v114, s70, v114
    v_xor_b32 v115, s70, v115
    v_xor_b32 v116, s70, v116
    v_xor_b32 v117, s70, v117
    v_xor_b32 v118, s70, v118
    v_xor_b32 v119, s70, v119
    v_xor_b32 v120, s70, v120
    v_xor_b32 v121, s70, v121
    v_xor_b32 v122, s70, v122
    v_xor_b32 v123, s70, v123
    v_xor_b32 v124, s70, v124
    v_xor_b32 v125, s70, v125
    v_xor_b32 v126, s70, v126
    v_xor_b32 v127, s70, v127
    v_or3_b32 v4, v112, v113, v114
    v_or3_b32 v4, v4, v115, v116
    v_or3_b32 v4, v4, v117, v118
    v_or3_b32 v4, v4, v119, v120
    v_or3_b32 v4, v4, v121, v122
    v_or3_b32 v4, v4, v123, v124
    v_or3_b32 v4, v4, v125, v126
    v_or3_b32 v4, v4, v127, v127
    v_and_b32 v4, 0xff, v4
    v_cmp_ne_u32 vcc, 0, v4
    s_cbranch_scc0 L_o_ok
    s_cbranch_vccnz L_o_retry
L_o_ok:
    v_pk_mul_f32 v[32:33], v[112:113], v[148:149] op_sel:[0,0] op_sel_hi:[1,0]
    v_pk_mul_f32 v[34:35], v[114:115], v[148:149] op_sel:[0,0] op_sel_hi:[1,0]
    v_pk_fma_f32 v[32:33], v[116:117], v[148:149], v[32:33] op_sel:[0,1,0] op_sel_hi:[1,1,1]
    v_pk_fma_f32 v[34:35], v[118:119], v[148:149], v[34:35] op_sel:[0,1,0] op_sel_hi:[1,1,1]
    v_pk_fma_f32 v[32:33], v[120:121], v[150:151], v[32:33] op_sel:[0,0,0] op_sel_hi:[1,0,1]
    v_pk_fma_f32 v[34:35], v[122:123], v[150:151], v[34:35] op_sel:[0,0,0] op_sel_hi:[1,0,1]
    v_pk_fma_f32 v[32:33], v[124:125], v[150:151], v[32:33] op_sel:[0,1,0] op_sel_hi:[1,1,1]
    v_pk_fma_f32 v[34:35], v[126:127], v[150:151], v[34:35] op_sel:[0,1,0] op_sel_hi:[1,1,1]
    v_cvt_pk_bf16_f32 v36, v32, v33
    v_cvt_pk_bf16_f32 v37, v34, v35
    ds_write_b64 v24, v[36:37]
    s_waitcnt lgkmcnt(0)
    s_barrier
    ds_read_b128 v[48:51], v25 offset:0
    ds_read_b128 v[52:55], v25 offset:64
    ds_read_b128 v[56:59], v25 offset:128
    ds_read_b128 v[60:63], v25 offset:192
    ds_read_b128 v[64:67], v25 offset:256
    ds_read_b128 v[68:71], v25 offset:320
    ds_read_b128 v[72:75], v25 offset:384
    ds_read_b128 v[76:79], v25 offset:448
    s_waitcnt lgkmcnt(7)
    v_mfma_f32_16x16x32_bf16 v[80:83], v[160:163], v[48:51], 0
    s_waitcnt lgkmcnt(6)
    v_mfma_f32_16x16x32_bf16 v[80:83], v[164:167], v[52:55], v[80:83]
    s_waitcnt lgkmcnt(5)
    v_mfma_f32_16x16x32_bf16 v[80:83], v[168:171], v[56:59], v[80:83]
    s_waitcnt lgkmcnt(4)
    v_mfma_f32_16x16x32_bf16 v[80:83], v[172:175], v[60:63], v[80:83]
    s_waitcnt lgkmcnt(3)
    v_mfma_f32_16x16x32_bf16 v[80:83], v[176:179], v[64:67], v[80:83]
    s_waitcnt lgkmcnt(2)
    v_mfma_f32_16x16x32_bf16 v[80:83], v[180:183], v[68:71], v[80:83]
    s_waitcnt lgkmcnt(1)
    v_mfma_f32_16x16x32_bf16 v[80:83], v[184:187], v[72:75], v[80:83]
    s_waitcnt lgkmcnt(0)
    v_mfma_f32_16x16x32_bf16 v[80:83], v[188:191], v[76:79], v[80:83]
    v_mfma_f32_16x16x32_bf16 v[84:87], v[192:195], v[48:51], 0
    v_mfma_f32_16x16x32_bf16 v[84:87], v[196:199], v[52:55], v[84:87]
    v_mfma_f32_16x16x32_bf16 v[84:87], v[200:203], v[56:59], v[84:87]
    v_mfma_f32_16x16x32_bf16 v[84:87], v[204:207], v[60:63], v[84:87]
    v_mfma_f32_16x16x32_bf16 v[84:87], v[208:211], v[64:67], v[84:87]
    v_mfma_f32_16x16x32_bf16 v[84:87], v[212:215], v[68:71], v[84:87]
    v_mfma_f32_16x16x32_bf16 v[84:87], v[216:219], v[72:75], v[84:87]
    s_nop 0
    v_bfi_b32 v80, v144, v80, s70
    v_bfi_b32 v81, v144, v81, s70
    v_bfi_b32 v82, v144, v82, s70
    v_bfi_b32 v83, v144, v83, s70
    s_mov_b64 exec, s[56:57]
    buffer_store_dwordx4 v[80:83], v15, s[60:63], s65 offen sc1
    s_mov_b64 exec, -1
    s_add_u32 s65, s65, 40960
    v_mfma_f32_16x16x32_bf16 v[84:87], v[220:223], v[76:79], v[84:87]
    v_mfma_f32_16x16x32_bf16 v[88:91], v[224:227], v[48:51], 0
    v_mfma_f32_16x16x32_bf16 v[88:91], v[228:231], v[52:55], v[88:91]
    v_mfma_f32_16x16x32_bf16 v[88:91], v[232:235], v[56:59], v[88:91]
    v_mfma_f32_16x16x32_bf16 v[88:91], v[236:239], v[60:63], v[88:91]
    v_mfma_f32_16x16x32_bf16 v[88:91], v[240:243], v[64:67], v[88:91]
    v_mfma_f32_16x16x32_bf16 v[88:91], v[244:247], v[68:71], v[88:91]
    v_mfma_f32_16x16x32_bf16 v[88:91], v[248:251], v[72:75], v[88:91]
    s_nop 0
    v_bfi_b32 v84, v144, v84, s70
    v_bfi_b32 v85, v144, v85, s70
    v_bfi_b32 v86, v144, v86, s70
    v_bfi_b32 v87, v144, v87, s70
    s_mov_b64 exec, s[56:57]
    buffer_store_dwordx4 v[84:87], v15, s[60:63], s65 offen sc1
    s_mov_b64 exec, -1
    s_add_u32 s65, s65, 40960
    v_mfma_f32_16x16x32_bf16 v[88:91], v[252:255], v[76:79], v[88:91]
    s_mov_b64 exec, s[56:57]
    s_nop 6
    v_bfi_b32 v88, v144, v88, s70
    v_bfi_b32 v89, v144, v89, s70
    v_bfi_b32 v90, v144, v90, s70
    v_bfi_b32 v91, v144, v91, s70
    buffer_store_dwordx4 v[88:91], v15, s[60:63], s65 offen sc1
L_c_done:
L_end:
    s_endpgm
L_p1_far:
    buffer_store_dwordx4 v[32:35], v15, s[60:63], s64 offen sc1
    buffer_store_dwordx4 v[36:39], v15, s[60:63], s64 offen offset:256 sc1
    s_branch L_p1_pub
L_st_far:
    buffer_store_dwordx4 v[4:7], v31, s[60:63], s75 offen sc1
    s_branch L_st_pub
L_o_far:
    buffer_store_dwordx4 v[40:43], v15, s[60:63], s74 offen sc1
    buffer_store_dwordx4 v[44:47], v15, s[60:63], s74 offen offset:128 sc1
    s_branch L_o_pub
L_code_end:
.section .rodata,"a"
.p2align 6
.amdhsa_kernel gated_mix__sliding_block_cached__glu_gated_reglu__decode_kernel
  .amdhsa_next_free_vgpr 256
  .amdhsa_next_free_sgpr 102
  .amdhsa_accum_offset 256
  .amdhsa_group_segment_fixed_size 0
  .amdhsa_kernarg_size 104
  .amdhsa_user_sgpr_count 2
  .amdhsa_user_sgpr_kernarg_segment_ptr 1
  .amdhsa_system_sgpr_workgroup_id_x 1
.end_amdhsa_kernel
.text
```
